```python
import torch

def _softmax(x, axis=-1):
    return torch.softmax(x, dim=axis)
def _gelu(x):
    return torch.nn.functional.gelu(x, approximate="tanh")
def _silu(x):
    return torch.nn.functional.silu(x)
def _sigmoid(x):
    return torch.sigmoid(x)
def _layernorm(x, axis=-1, eps=1e-5):
    m = x.mean(dim=axis, keepdim=True)
    v = x.var(dim=axis, keepdim=True, unbiased=False)
    return (x - m) / torch.sqrt(v + eps)
def _scatter_add(tgt, idx, src, axis=0):
    return tgt.clone().index_add_(axis, idx, src)
def _segment_sum(src, seg, n):
    out = torch.zeros((n,) + src.shape[1:], dtype=src.dtype)
    return out.index_add_(0, seg, src)
def _pad(x, pw):
    flat = tuple(v for pair in reversed(pw) for v in pair)
    return torch.nn.functional.pad(x, flat)

kernel_name = 'concat_heads__softmax_full_mha__ssm_conv_h3__prompt'

def setup_inputs():

    _w = (lambda a: (lambda t: t.to(torch.bfloat16) if t.is_floating_point() else t)(torch.as_tensor(a)))
    def _A_setup():
        B, S, D = 1, 2048, 448
        return {
            "x": _w((lambda *s: torch.randn(*s, dtype=torch.bfloat16) * 0.2)(B, S, D)),
            "wqkv": _w((lambda *s: torch.randn(*s, dtype=torch.bfloat16) * 0.2)(D, 3 * D)),
            "wo": _w((lambda *s: torch.randn(*s, dtype=torch.bfloat16) * 0.05)(D, D)),
        }
    _A_in = _A_setup()

    def _B_setup():
        B, S, D = 1, 2048, 448
        ks = 4
        return {
            "q": _w((lambda *s: torch.randn(*s, dtype=torch.bfloat16) * 0.05)(B, S, D)),
            "k": _w((lambda *s: torch.randn(*s, dtype=torch.bfloat16) * 0.4)(B, S, D)),
            "v": _w((lambda *s: torch.randn(*s, dtype=torch.bfloat16) * 0.4)(B, S, D)),
            "shift_k": _w((lambda *s: torch.randn(*s, dtype=torch.bfloat16) * 0.4)(D, ks) * 0.5),
            "ssm_k": _w((lambda *s: torch.randn(*s, dtype=torch.bfloat16) * 0.8)(D, S) * (1.0 / S ** 0.5)),
            "ssm_D": _w((lambda *s: torch.randn(*s, dtype=torch.bfloat16) * 0.4)(D)),
        }
    _B_in = _B_setup()

    return {
        "A_x": _A_in["x"],
        "A_wqkv": _A_in["wqkv"],
        "A_wo": _A_in["wo"],
        "B_q": _B_in["q"],
        "B_k": _B_in["k"],
        "B_v": _B_in["v"],
        "B_shift_k": _B_in["shift_k"],
        "B_ssm_k": _B_in["ssm_k"],
        "B_ssm_D": _B_in["ssm_D"],
    }

def reference(A_x, A_wqkv, A_wo, B_q, B_k, B_v, B_shift_k, B_ssm_k, B_ssm_D):
    def _A_ref(x, wqkv, wo):
        B, S, D = x.shape
        H = 16; Dh = D // H
        qkv = (lambda x, *d: x.permute(*d))((x @ wqkv).reshape(B, S, 3, H, Dh), 2, 0, 3, 1, 4)
        q, k, v = qkv[0], qkv[1], qkv[2]
        scale = Dh ** -0.5
        scores = torch.einsum("bhqd,bhkd->bhqk", q, k) * scale
        p = _softmax(scores, axis=-1)
        o = torch.einsum("bhqk,bhkd->bhqd", p, v)
        return (lambda x, *d: x.permute(*d))(o, 0, 2, 1, 3).reshape(B, S, D) @ wo

    def _B_ref(q, k, v, shift_k, ssm_k, ssm_D):
        B, S, D = q.shape
        ks = shift_k.shape[-1]
        k_pad = _pad(k, ((0, 0), (ks - 1, 0), (0, 0)))
        k_shift = torch.zeros_like(k)
        for t in range(ks):
            k_shift = k_shift + k_pad[:, t:t + S, :] * shift_k[:, ks - 1 - t][None, None, :]
        kv = k_shift * v
        L = 2 * S
        kv_pad = _pad(kv, ((0, 0), (0, S), (0, 0)))
        kf_pad = _pad(ssm_k, ((0, 0), (0, S)))
        kv_f = (lambda x, axes=(-2,-1): torch.fft.rfft2(x.float(), dim=axes))(kv_pad[:, None, :, :], axes=(1, 2))
        kf_f = (lambda x, axes=(-2,-1): torch.fft.rfft2(x.float(), dim=axes))(kf_pad[:, None, :], axes=(1, 2))
        kf_f = (lambda x, *d: x.permute(*d))(kf_f, 1, 2, 0)
        y_f = kv_f * kf_f[None, :, :, :]
        y = (lambda x, s, axes=(-2,-1): torch.fft.irfft2(x, s=s, dim=axes).to(torch.bfloat16))(y_f, (1, L), axes=(1, 2))[:, 0, :S, :]
        y = y + kv * ssm_D[None, None, :]
        return q * y

    a = _A_ref(A_x, A_wqkv, A_wo)
    b = _B_ref(B_q, B_k, B_v, B_shift_k, B_ssm_k, B_ssm_D)
    return torch.concatenate([a, b], axis=-1)
```

```asm
; @launch grid=(256,1,1) block=(512,1,1) lds=163840
.amdgcn_target "amdgcn-amd-amdhsa--gfx950"
.text
.globl concat_heads__softmax_full_mha__ssm_conv_h3__prompt_kernel
.p2align 8
.type concat_heads__softmax_full_mha__ssm_conv_h3__prompt_kernel,@function
concat_heads__softmax_full_mha__ssm_conv_h3__prompt_kernel:
    s_cmp_ge_u32 s2, 256
    s_cbranch_scc1 L_end
    s_load_dwordx2 s[20:21], s[0:1], 32
    s_load_dwordx2 s[4:5], s[0:1], 0
    s_load_dwordx2 s[24:25], s[0:1], 40
    s_load_dwordx2 s[28:29], s[0:1], 48
    s_load_dwordx2 s[8:9], s[0:1], 8
    s_load_dwordx2 s[40:41], s[0:1], 88
    s_load_dwordx2 s[44:45], s[0:1], 64
    s_getpc_b64 s[62:63]
L_pc:
    v_lshrrev_b32 v1, 6, v0
    v_and_b32 v0, 63, v0
    s_bfe_u32 s57, s2, 0x30003
    v_lshl_add_u32 v2, s57, 6, v0
    s_sub_u32 s62, s62, L_pc-concat_heads__softmax_full_mha__ssm_conv_h3__prompt_kernel
    s_subb_u32 s63, s63, 0
    v_mul_u32_u24 v2, 44, v2
    v_mov_b32 v3, s63
    v_add_co_u32 v2, vcc, s62, v2
    v_readfirstlane_b32 s47, v1
    v_lshrrev_b32 v130, 4, v0
    v_addc_co_u32 v3, vcc, 0, v3, vcc
    global_load_dword v255, v[2:3], off
    s_and_b32 s55, s47, 3
    s_cmp_lt_u32 s47, 4
    s_cbranch_scc1 L_uprep
    s_and_b32 s59, s2, 1
    s_bfe_u32 s60, s2, 0x30003
    s_lshl3_add_u32 s48, s59, s60
    s_bfe_u32 s59, s2, 0x20001
    s_lshr_b32 s60, s2, 6
    s_lshl2_add_u32 s59, s59, s60
    s_lshl2_add_u32 s49, s59, s55
    s_and_b32 s59, s55, 1
    s_lshr_b32 s60, s55, 1
    s_lshl2_add_u32 s59, s60, s59
    s_add_u32 s59, s59, 4
    s_lshl_b32 s69, s59, 14
    s_mov_b32 s6, 1835008
    s_mov_b32 s7, 0x20000
    s_mov_b32 s10, 1204224
    s_mov_b32 s11, 0x20000
    v_lshrrev_b32 v128, 3, v0
    s_lshl_b32 s57, s49, 5
    v_add_u32 v128, s57, v128
    v_mul_u32_u24 v128, 896, v128
    v_and_b32 v129, 7, v0
    v_xor_b32 v129, v129, v130
    v_lshl_add_u32 v2, v129, 4, v128
    v_xor_b32 v129, 4, v129
    v_lshl_add_u32 v3, v129, 4, v128
    v_add_u32 v3, 6144, v3
    v_add_u32 v4, 12288, v2
    v_add_u32 v5, 12288, v3
    s_lshr_b32 s60, s2, 6
    s_mul_i32 s60, s60, 1
    s_add_u32 s60, s60, s48
    s_and_b32 s60, s60, 7
    s_lshl_b32 s60, s60, 2
    s_lshr_b32 s65, 0x40404040, s60
    s_and_b32 s65, s65, 7
    s_waitcnt lgkmcnt(0)
    s_add_u32 m0, s69, 0
    s_add_u32 s66, s65, 0
    s_cmp_ge_u32 s66, 7
    s_cselect_b32 s71, 7, 0
    s_sub_u32 s66, s66, s71
    s_mul_i32 s66, s66, 128
    buffer_load_dwordx4 v2, s[4:7], s66 offen offset:0 lds
    buffer_load_dwordx4 v3, s[4:7], s66 offen offset:1024 lds
    buffer_load_dwordx4 v4, s[4:7], s66 offen offset:2048 lds
    buffer_load_dwordx4 v5, s[4:7], s66 offen offset:3072 lds
    s_branch L_loader
L_uprep:
    s_setprio 3
    s_and_b32 s59, s2, 7
    s_lshr_b32 s60, s2, 5
    s_lshl3_add_u32 s50, s59, s60
    s_bfe_u32 s51, s2, 0x20003
    v_and_b32 v129, 15, v0
    v_min_u32 v129, 13, v129
    s_lshl2_add_u32 s57, s51, s55
    s_mul_i32 s58, s57, 56
    s_mul_i32 s59, s50, 28672
    s_add_u32 s59, s59, s58
    v_mul_u32_u24 v210, 7168, v130
    v_lshl_add_u32 v132, v129, 2, v210
    v_add_u32 v211, s59, v132
    s_mov_b32 s22, 1835008
    s_mov_b32 s23, 0x20000
    s_mov_b32 s26, 1835008
    s_mov_b32 s27, 0x20000
    s_mov_b32 s30, 3584
    s_mov_b32 s31, 0x20000
    v_subrev_u32 v135, 2688, v211
    s_lshl_b32 s58, s58, 2
    v_lshl_add_u32 v137, v129, 4, s58
    s_movk_i32 s62, 3584
    s_waitcnt lgkmcnt(0)
    buffer_load_dwordx4 v[160:163], v137, s[28:31], 0 offen
    buffer_load_dword v140, v135, s[20:23], 0 offen offset:0
    buffer_load_dword v141, v135, s[20:23], 0 offen offset:896
    buffer_load_dword v142, v135, s[20:23], 0 offen offset:1792
    buffer_load_dword v143, v211, s[20:23], 0 offen offset:0
    buffer_load_dword v144, v211, s[20:23], 0 offen offset:896
    buffer_load_dword v145, v211, s[20:23], 0 offen offset:1792
    buffer_load_dword v146, v211, s[20:23], 0 offen offset:2688
    buffer_load_dword v147, v211, s[20:23], s62 offen offset:0
    buffer_load_dword v148, v211, s[20:23], s62 offen offset:896
    buffer_load_dword v149, v211, s[20:23], s62 offen offset:1792
    buffer_load_dword v150, v211, s[20:23], s62 offen offset:2688
    buffer_load_dword v152, v211, s[24:27], 0 offen offset:0
    buffer_load_dword v153, v211, s[24:27], 0 offen offset:896
    buffer_load_dword v154, v211, s[24:27], 0 offen offset:1792
    buffer_load_dword v155, v211, s[24:27], 0 offen offset:2688
    buffer_load_dword v156, v211, s[24:27], s62 offen offset:0
    buffer_load_dword v157, v211, s[24:27], s62 offen offset:896
    buffer_load_dword v158, v211, s[24:27], s62 offen offset:1792
    buffer_load_dword v159, v211, s[24:27], s62 offen offset:2688
    s_setprio 0
    s_and_b32 s59, s2, 1
    s_bfe_u32 s60, s2, 0x30003
    s_lshl3_add_u32 s48, s59, s60
    s_bfe_u32 s59, s2, 0x20001
    s_lshr_b32 s60, s2, 6
    s_lshl2_add_u32 s59, s59, s60
    s_lshl2_add_u32 s49, s59, s55
    s_and_b32 s59, s55, 1
    s_lshr_b32 s60, s55, 1
    s_lshl2_add_u32 s59, s60, s59
    s_add_u32 s59, s59, 4
    s_lshl_b32 s69, s59, 14
    v_lshlrev_b32 v1, 4, v0
    s_sub_u32 s59, s2, 32
    s_cmp_lt_u32 s2, 224
    s_cselect_b32 s52, s2, s59
    s_load_dword s56, s[40:41], 0
    s_lshl_b32 s57, s52, 2
    s_load_dword s73, s[44:45], s57
    s_load_dwordx2 s[32:33], s[0:1], 56
    s_load_dwordx2 s[12:13], s[0:1], 16
    s_load_dwordx2 s[16:17], s[0:1], 24
    s_load_dwordx2 s[36:37], s[0:1], 72
    s_mov_b32 s14, 401408
    s_mov_b32 s15, 0x20000
    s_mov_b32 s18, 1835008
    s_mov_b32 s19, 0x20000
    s_mov_b32 s38, 3670016
    s_mov_b32 s39, 0x20000
    s_mov_b32 s42, 13631488
    s_mov_b32 s43, 0x20000
    v_add_u32 v210, v210, v211
    v_lshlrev_b32 v133, 7, v129
    v_lshl_add_u32 v209, v130, 4, v133
    s_lshl2_add_u32 s61, s51, s55
    s_mul_i32 s58, s61, 1792
    s_mul_i32 s60, s50, 28672
    s_add_u32 s31, s58, s60
    s_add_u32 s31, s31, 9437184
    s_and_b32 s59, s2, 7
    s_lshr_b32 s60, s2, 7
    s_lshl1_add_u32 s53, s59, s60
    s_bfe_u32 s54, s2, 0x40003
    s_mov_b32 s70, 0
    s_lshr_b32 s64, s47, 2
    s_mul_i32 s72, s64, 98304
    v_and_b32 v132, 3, v0
    v_sub_u32 v133, 3, v132
    v_mul_u32_u24 v133, 4160, v133
    v_and_b32 v134, 12, v0
    v_lshl_add_u32 v133, v134, 1, v133
    v_and_b32 v134, 0x30, v0
    v_sub_u32 v133, v133, v134
    s_lshl_b32 s57, s55, 7
    s_add_u32 s58, s57, s72
    s_add_u32 s58, s58, 56
    v_add_u32 v192, s58, v133
    v_and_b32 v139, 15, v0
    v_lshl_add_u32 v133, v139, 5, v134
    s_sub_u32 s58, s72, s57
    s_add_u32 s58, s58, 17056
    v_add_u32 v193, s58, v133
    v_lshrrev_b32 v131, 5, v0
    v_lshlrev_b32 v133, 7, v131
    v_xor_b32 v133, v133, v1
    s_lshl_b32 s57, s55, 13
    s_add_u32 s57, s57, s72
    v_add_u32 v194, s57, v133
    v_bfe_u32 v135, v0, 2, 1
    v_mul_u32_u24 v136, 98304, v135
    v_lshrrev_b32 v137, 3, v0
    v_lshl_add_u32 v138, v137, 2, v132
    v_lshrrev_b32 v133, 1, v138
    v_and_b32 v134, 1, v0
    v_mul_u32_u24 v134, 40, v134
    v_xor_b32 v133, v133, v134
    v_lshl_add_u32 v133, v133, 4, v136
    s_lshl_b32 s57, s47, 10
    v_add_u32 v195, s57, v133
    v_lshl_add_u32 v133, v138, 4, v136
    s_lshl_b32 s57, s47, 9
    s_add_u32 s57, s57, 17152
    v_add_u32 v196, s57, v133
    v_mul_u32_u24 v133, 28672, v137
    v_and_b32 v134, 7, v0
    v_lshl_add_u32 v197, v134, 4, v133
    v_lshlrev_b32 v134, 2, v134
    v_add_u32 v205, 102272, v134
    s_mul_i32 s57, s47, 229376
    s_lshl_b32 s58, s52, 7
    s_add_u32 s57, s57, s58
    s_add_u32 s26, s57, 9437184
    s_lshl_b32 s78, s53, 18
    s_add_u32 s78, s78, 3145728
    s_lshl_b32 s28, s47, 12
    s_add_u32 s3, s78, s28
    s_min_u32 s57, s47, 6
    s_lshl_b32 s79, s57, 10
    s_lshl_b32 s58, s57, 6
    v_add_u32 v133, s58, v0
    v_mul_u32_u24 v134, 4682, v133
    v_lshrrev_b32 v134, 16, v134
    v_mul_u32_u24 v136, 14, v134
    v_sub_u32 v133, v133, v136
    v_bfe_u32 v136, v134, 1, 2
    v_and_b32 v138, 1, v134
    v_lshl_add_u32 v136, v138, 2, v136
    v_and_or_b32 v134, v134, 24, v136
    v_mul_u32_u24 v134, 896, v134
    v_lshl_add_u32 v133, v133, 4, v134
    s_mul_i32 s58, s51, 224
    v_add_u32 v202, s58, v133
    s_and_b32 s57, s47, 1
    s_lshl1_add_u32 s57, s64, s57
    s_lshl_b32 s57, s57, 13
    s_add_u32 s57, s57, 32768
    v_add_u32 v199, s57, v1
    v_add_u32 v200, 0x10000, v199
    s_lshl_b32 s57, s55, 11
    s_add_u32 s57, s57, 131072
    v_add_u32 v201, s57, v1
    s_lshl_b32 s57, s55, 12
    s_add_u32 s57, s57, 114688
    v_add_u32 v203, s57, v1
    s_lshl_b32 s58, s47, 2
    s_add_u32 s58, s58, 102272
    v_mov_b32 v204, s58
    s_lshl_b32 s60, s54, 2
    s_add_u32 s60, s60, s55
    s_lshl_b32 s57, s60, 4
    s_add_u32 s57, s57, s53
    s_lshl_b32 s57, s57, 11
    s_add_u32 s27, s57, 11534336
    s_lshl4_add_u32 s57, s53, s54
    s_lshl3_add_u32 s57, s57, s47
    s_lshl_b32 s57, s57, 10
    s_add_u32 s30, s57, 1048576
    v_cmp_eq_u32 vcc, 0, v135
    s_waitcnt lgkmcnt(0)
    s_mul_i32 s46, s56, 1664525
    s_add_u32 s46, s46, 1013904223
    s_lshl_b32 s57, s73, 16
    s_and_b32 s58, s73, 0xffff0000
    v_mov_b32 v133, s57
    v_mov_b32 v134, s58
    v_cndmask_b32 v198, v134, v133, vcc
    v_mov_b32 v15, s46
    s_lshl_b32 s57, s64, 10
    s_add_u32 s44, s27, s57
    s_and_b32 s57, s47, 6
    s_add_u32 s57, s57, s47
    s_lshl_b32 s45, s57, 11
    s_sub_u32 s29, s31, 2097152
    s_lshl_b32 s61, s55, 11
    s_add_u32 s61, s61, 122880
    v_and_b32 v136, 7, v129
    v_lshlrev_b32 v136, 4, v136
    v_xor_b32 v136, v136, v209
    v_add_u32 v136, s61, v136
    v_xor_b32 v138, 64, v136
    v_lshlrev_b32 v137, 4, v137
    v_xor_b32 v137, v137, v1
    v_add_u32 v137, s61, v137
    s_and_b32 s63, s48, 1
    s_lshl_b32 s63, s63, 3
    v_and_b32 v128, 31, v0
    v_bfe_u32 v129, v0, 1, 3
    v_xor_b32 v129, v129, v131
    v_lshlrev_b32 v128, 7, v128
    v_lshl_add_u32 v128, v129, 4, v128
    v_add_u32 v14, s69, v128
    v_bfe_u32 v128, v0, 2, 2
    v_lshl_add_u32 v128, v131, 3, v128
    v_mul_u32_u24 v128, 192, v128
    v_and_b32 v129, 1, v130
    v_lshl_add_u32 v128, v129, 5, v128
    v_lshl_add_u32 v128, v132, 3, v128
    s_add_u32 s63, s63, 98304
    v_add_u32 v13, s63, v128
    v_mov_b32 v9, v14
    v_mov_b32 v208, 0
    v_xor_b32 v10, 32, v14
    v_xor_b32 v11, 64, v14
    v_xor_b32 v12, 0x60, v14
    s_lshr_b32 s57, s49, 2
    s_lshl4_add_u32 s57, s48, s57
    s_lshl_b32 s57, s57, 4
    s_add_u32 s20, s57, 393216
    s_mul_i32 s64, s48, 3
    s_add_u32 s60, s64, 0
    s_and_b32 s57, s60, 15
    s_lshl_b32 s57, s57, 6
    s_add_u32 s57, s57, s49
    s_cmp_lt_u32 s60, 16
    s_cselect_b32 s58, 11, 12
    s_mov_b32 s59, 3145728
    s_cselect_b32 s59, 1048576, s59
    s_lshl_b32 s57, s57, s58
    s_add_u32 s21, s57, s59
    s_add_u32 s60, s64, 1
    s_and_b32 s57, s60, 15
    s_lshl_b32 s57, s57, 6
    s_add_u32 s57, s57, s49
    s_cmp_lt_u32 s60, 16
    s_cselect_b32 s58, 11, 12
    s_mov_b32 s59, 3145728
    s_cselect_b32 s59, 1048576, s59
    s_lshl_b32 s57, s57, s58
    s_add_u32 s22, s57, s59
    s_add_u32 s60, s64, 2
    s_and_b32 s57, s60, 15
    s_lshl_b32 s57, s57, 6
    s_add_u32 s57, s57, s49
    s_cmp_lt_u32 s60, 16
    s_cselect_b32 s58, 11, 12
    s_mov_b32 s59, 3145728
    s_cselect_b32 s59, 1048576, s59
    s_lshl_b32 s57, s57, s58
    s_add_u32 s23, s57, s59
    s_mov_b32 s24, 1065369472
    s_movk_i32 s25, 0x3f80
    s_mov_b32 s34, 0x3e8b97f6
    s_mov_b32 s35, 0x3e8b97f6
    s_mov_b32 s74, 0xf0000000
    s_mov_b32 s75, 0xf0000000
    s_mov_b32 s76, 1065369472
    s_mov_b32 s77, 1065369472
    v_mov_b64 v[16:17], 0
    v_mov_b64 v[18:19], 0
    v_mov_b64 v[20:21], 0
    v_mov_b64 v[22:23], 0
    v_mov_b64 v[24:25], 0
    v_mov_b64 v[26:27], 0
    v_mov_b64 v[28:29], 0
    v_mov_b64 v[30:31], 0
    v_mov_b64 v[32:33], 0
    v_mov_b64 v[34:35], 0
    v_mov_b64 v[36:37], 0
    v_mov_b64 v[38:39], 0
    v_mov_b64 v[40:41], 0
    v_mov_b64 v[42:43], 0
    v_mov_b64 v[44:45], 0
    v_mov_b64 v[46:47], 0
    v_mov_b64 v[48:49], 0
    v_mov_b64 v[50:51], 0
    v_mov_b64 v[52:53], 0
    v_mov_b64 v[54:55], 0
    v_mov_b64 v[56:57], 0
    v_mov_b64 v[58:59], 0
    v_mov_b64 v[60:61], 0
    v_mov_b64 v[62:63], 0
    v_mov_b64 v[80:81], 0
    v_mov_b64 v[82:83], 0
    v_mov_b64 v[84:85], 0
    v_mov_b64 v[86:87], 0
    v_mov_b64 v[88:89], 0
    v_mov_b64 v[90:91], 0
    v_mov_b64 v[92:93], 0
    v_mov_b64 v[94:95], 0
    v_mov_b64 v[96:97], 0
    v_mov_b64 v[98:99], 0
    v_mov_b64 v[100:101], 0
    v_mov_b64 v[102:103], 0
    v_mov_b64 v[104:105], 0
    v_mov_b64 v[106:107], 0
    v_mov_b64 v[108:109], 0
    v_mov_b64 v[110:111], 0
    v_mov_b64 v[112:113], 0
    v_mov_b64 v[114:115], 0
    v_mov_b64 v[116:117], 0
    v_mov_b64 v[118:119], 0
    v_mov_b64 v[120:121], 0
    v_mov_b64 v[122:123], 0
    v_mov_b64 v[124:125], 0
    v_mov_b64 v[126:127], 0
    s_mov_b32 s65, 0
    s_setprio 2
    s_waitcnt vmcnt(8)
    v_lshlrev_b32 v212, 16, v160
    v_lshlrev_b32 v213, 16, v162
    v_and_b32 v214, 0xffff0000, v160
    v_and_b32 v215, 0xffff0000, v162
    v_lshlrev_b32 v216, 16, v161
    v_lshlrev_b32 v217, 16, v163
    v_and_b32 v218, 0xffff0000, v161
    v_and_b32 v219, 0xffff0000, v163
    v_lshlrev_b32 v164, 16, v140
    v_and_b32 v165, 0xffff0000, v140
    v_lshlrev_b32 v166, 16, v141
    v_and_b32 v167, 0xffff0000, v141
    v_lshlrev_b32 v168, 16, v142
    v_and_b32 v169, 0xffff0000, v142
    v_lshlrev_b32 v170, 16, v143
    v_and_b32 v171, 0xffff0000, v143
    v_lshlrev_b32 v172, 16, v144
    v_and_b32 v173, 0xffff0000, v144
    v_lshlrev_b32 v174, 16, v145
    v_and_b32 v175, 0xffff0000, v145
    v_lshlrev_b32 v176, 16, v146
    v_and_b32 v177, 0xffff0000, v146
    v_lshlrev_b32 v178, 16, v147
    v_and_b32 v179, 0xffff0000, v147
    v_lshlrev_b32 v180, 16, v148
    v_and_b32 v181, 0xffff0000, v148
    v_lshlrev_b32 v182, 16, v149
    v_and_b32 v183, 0xffff0000, v149
    v_lshlrev_b32 v184, 16, v150
    v_and_b32 v185, 0xffff0000, v150
    v_pk_mul_f32 v[220:221], v[164:165], v[218:219]
    v_pk_mul_f32 v[222:223], v[166:167], v[218:219]
    v_pk_mul_f32 v[224:225], v[168:169], v[218:219]
    v_pk_mul_f32 v[226:227], v[170:171], v[218:219]
    v_pk_mul_f32 v[228:229], v[172:173], v[218:219]
    v_pk_mul_f32 v[230:231], v[174:175], v[218:219]
    v_pk_mul_f32 v[232:233], v[176:177], v[218:219]
    v_pk_mul_f32 v[234:235], v[178:179], v[218:219]
    v_pk_fma_f32 v[220:221], v[166:167], v[216:217], v[220:221]
    v_pk_fma_f32 v[222:223], v[168:169], v[216:217], v[222:223]
    v_pk_fma_f32 v[224:225], v[170:171], v[216:217], v[224:225]
    v_pk_fma_f32 v[226:227], v[172:173], v[216:217], v[226:227]
    v_pk_fma_f32 v[228:229], v[174:175], v[216:217], v[228:229]
    v_pk_fma_f32 v[230:231], v[176:177], v[216:217], v[230:231]
    v_pk_fma_f32 v[232:233], v[178:179], v[216:217], v[232:233]
    v_pk_fma_f32 v[234:235], v[180:181], v[216:217], v[234:235]
    v_pk_fma_f32 v[220:221], v[168:169], v[214:215], v[220:221]
    v_pk_fma_f32 v[222:223], v[170:171], v[214:215], v[222:223]
    v_pk_fma_f32 v[224:225], v[172:173], v[214:215], v[224:225]
    v_pk_fma_f32 v[226:227], v[174:175], v[214:215], v[226:227]
    v_pk_fma_f32 v[228:229], v[176:177], v[214:215], v[228:229]
    v_pk_fma_f32 v[230:231], v[178:179], v[214:215], v[230:231]
    v_pk_fma_f32 v[232:233], v[180:181], v[214:215], v[232:233]
    v_pk_fma_f32 v[234:235], v[182:183], v[214:215], v[234:235]
    v_pk_fma_f32 v[220:221], v[170:171], v[212:213], v[220:221]
    v_pk_fma_f32 v[222:223], v[172:173], v[212:213], v[222:223]
    v_pk_fma_f32 v[224:225], v[174:175], v[212:213], v[224:225]
    v_pk_fma_f32 v[226:227], v[176:177], v[212:213], v[226:227]
    v_pk_fma_f32 v[228:229], v[178:179], v[212:213], v[228:229]
    v_pk_fma_f32 v[230:231], v[180:181], v[212:213], v[230:231]
    v_pk_fma_f32 v[232:233], v[182:183], v[212:213], v[232:233]
    v_pk_fma_f32 v[234:235], v[184:185], v[212:213], v[234:235]
    s_waitcnt vmcnt(0)
    v_lshlrev_b32 v64, 16, v152
    v_and_b32 v65, 0xffff0000, v152
    v_lshlrev_b32 v66, 16, v153
    v_and_b32 v67, 0xffff0000, v153
    v_lshlrev_b32 v68, 16, v154
    v_and_b32 v69, 0xffff0000, v154
    v_lshlrev_b32 v70, 16, v155
    v_and_b32 v71, 0xffff0000, v155
    v_lshlrev_b32 v72, 16, v156
    v_and_b32 v73, 0xffff0000, v156
    v_lshlrev_b32 v74, 16, v157
    v_and_b32 v75, 0xffff0000, v157
    v_lshlrev_b32 v76, 16, v158
    v_and_b32 v77, 0xffff0000, v158
    v_lshlrev_b32 v78, 16, v159
    v_and_b32 v79, 0xffff0000, v159
    v_pk_mul_f32 v[220:221], v[220:221], v[64:65]
    v_pk_mul_f32 v[222:223], v[222:223], v[66:67]
    v_pk_mul_f32 v[224:225], v[224:225], v[68:69]
    v_pk_mul_f32 v[226:227], v[226:227], v[70:71]
    v_pk_mul_f32 v[228:229], v[228:229], v[72:73]
    v_pk_mul_f32 v[230:231], v[230:231], v[74:75]
    v_pk_mul_f32 v[232:233], v[232:233], v[76:77]
    v_pk_mul_f32 v[234:235], v[234:235], v[78:79]
    v_cvt_pk_bf16_f32 v236, v234, v232
    v_cvt_pk_bf16_f32 v237, v230, v228
    v_cvt_pk_bf16_f32 v238, v226, v224
    v_cvt_pk_bf16_f32 v239, v222, v220
    ds_write_b128 v136, v[236:239]
    v_cvt_pk_bf16_f32 v240, v235, v233
    v_cvt_pk_bf16_f32 v241, v231, v229
    v_cvt_pk_bf16_f32 v242, v227, v225
    v_cvt_pk_bf16_f32 v243, v223, v221
    ds_write_b128 v138, v[240:243]
    s_waitcnt lgkmcnt(0)
    ds_read_b128 v[236:239], v137
    ds_read_b128 v[240:243], v137 offset:1024
    s_waitcnt lgkmcnt(1)
    buffer_store_dwordx4 v[236:239], v1, s[40:43], s29 offen sc1
    s_mov_b32 exec_hi, 0xffff
    s_waitcnt lgkmcnt(0)
    buffer_store_dwordx4 v[240:243], v1, s[40:43], s29 offen offset:1024 sc1
    s_mov_b32 exec_hi, -1
    s_cmp_eq_u32 s48, 10
    s_cbranch_scc1 L_gemm1
    s_cmp_gt_u32 s48, 10
    s_cbranch_scc1 L_gemm2
L_gemm0:
    v_mfma_f32_32x32x16_bf16 v[48:63], v[92:95], v[80:83], v[48:63]
    s_barrier
    v_mfma_f32_32x32x16_bf16 v[16:31], v[100:103], v[96:99], v[16:31]
    ds_read_b128 v[64:67], v9
    ds_read_b64_tr_b16 v[68:69], v13 offset:0
    ds_read_b64_tr_b16 v[70:71], v13 offset:768
    v_mfma_f32_32x32x16_bf16 v[32:47], v[104:107], v[96:99], v[32:47]
    ds_read_b64_tr_b16 v[72:73], v13 offset:56
    ds_read_b64_tr_b16 v[74:75], v13 offset:824
    ds_read_b64_tr_b16 v[76:77], v13 offset:112
    v_mfma_f32_32x32x16_bf16 v[48:63], v[108:111], v[96:99], v[48:63]
    ds_read_b64_tr_b16 v[78:79], v13 offset:880
    ds_read_b128 v[80:83], v10
    ds_read_b64_tr_b16 v[84:85], v13 offset:3072
    v_mfma_f32_32x32x16_bf16 v[16:31], v[116:119], v[112:115], v[16:31]
    ds_read_b64_tr_b16 v[86:87], v13 offset:3840
    ds_read_b64_tr_b16 v[88:89], v13 offset:3128
    ds_read_b64_tr_b16 v[90:91], v13 offset:3896
    v_mfma_f32_32x32x16_bf16 v[32:47], v[120:123], v[112:115], v[32:47]
    ds_read_b64_tr_b16 v[92:93], v13 offset:3184
    ds_read_b64_tr_b16 v[94:95], v13 offset:3952
    ds_read_b128 v[96:99], v11
    v_mfma_f32_32x32x16_bf16 v[48:63], v[124:127], v[112:115], v[48:63]
    ds_read_b64_tr_b16 v[100:101], v13 offset:6144
    ds_read_b64_tr_b16 v[102:103], v13 offset:6912
    ds_read_b64_tr_b16 v[104:105], v13 offset:6200
    s_waitcnt lgkmcnt(11)
    v_mfma_f32_32x32x16_bf16 v[16:31], v[68:71], v[64:67], v[16:31]
    ds_read_b64_tr_b16 v[106:107], v13 offset:6968
    ds_read_b64_tr_b16 v[108:109], v13 offset:6256
    ds_read_b64_tr_b16 v[110:111], v13 offset:7024
    v_mfma_f32_32x32x16_bf16 v[32:47], v[72:75], v[64:67], v[32:47]
    ds_read_b128 v[112:115], v12
    ds_read_b64_tr_b16 v[116:117], v13 offset:9216
    ds_read_b64_tr_b16 v[118:119], v13 offset:9984
    v_mfma_f32_32x32x16_bf16 v[48:63], v[76:79], v[64:67], v[48:63]
    ds_read_b64_tr_b16 v[120:121], v13 offset:9272
    ds_read_b64_tr_b16 v[122:123], v13 offset:10040
    ds_read_b64_tr_b16 v[124:125], v13 offset:9328
    s_waitcnt lgkmcnt(13)
    v_mfma_f32_32x32x16_bf16 v[16:31], v[84:87], v[80:83], v[16:31]
    ds_read_b64_tr_b16 v[126:127], v13 offset:10096
    s_cmp_eq_u32 s65, 1
    s_movk_i32 s58, 12288
    s_cselect_b32 s58, 4294856704, s58
    s_add_u32 s65, s65, 1
    s_and_b32 s57, s65, 3
    s_lshl_b32 s57, s57, 12
    v_mfma_f32_32x32x16_bf16 v[32:47], v[88:91], v[80:83], v[32:47]
    v_add_u32 v13, s58, v13
    v_xor_b32 v9, s57, v14
    v_xor_b32 v10, 32, v9
    v_xor_b32 v11, 64, v9
    v_xor_b32 v12, 0x60, v9
    s_cmp_lt_u32 s65, 7
    s_waitcnt vmcnt(0) lgkmcnt(0)
    s_cbranch_scc1 L_gemm0
    v_mfma_f32_32x32x16_bf16 v[16:31], v[100:103], v[96:99], v[16:31]
    v_mfma_f32_32x32x16_bf16 v[48:63], v[92:95], v[80:83], v[48:63]
    v_mfma_f32_32x32x16_bf16 v[16:31], v[116:119], v[112:115], v[16:31]
    v_mfma_f32_32x32x16_bf16 v[32:47], v[104:107], v[96:99], v[32:47]
    v_mfma_f32_32x32x16_bf16 v[48:63], v[108:111], v[96:99], v[48:63]
    v_mfma_f32_32x32x16_bf16 v[32:47], v[120:123], v[112:115], v[32:47]
    v_mfma_f32_32x32x16_bf16 v[48:63], v[124:127], v[112:115], v[48:63]
    s_cmp_lt_u32 s64, 16
    s_cselect_b64 s[74:75], 0, s[24:25]
    s_cbranch_scc0 L_nosc0
    s_nop 4
    v_pk_mul_f32 v[16:17], v[16:17], s[34:35]
    v_pk_mul_f32 v[18:19], v[18:19], s[34:35]
    v_pk_mul_f32 v[20:21], v[20:21], s[34:35]
    v_pk_mul_f32 v[22:23], v[22:23], s[34:35]
    v_pk_mul_f32 v[24:25], v[24:25], s[34:35]
    v_pk_mul_f32 v[26:27], v[26:27], s[34:35]
    v_pk_mul_f32 v[28:29], v[28:29], s[34:35]
    v_pk_mul_f32 v[30:31], v[30:31], s[34:35]
L_nosc0:
    s_nop 4
    v_cvt_pk_bf16_f32 v128, v16, v17
    v_cvt_pk_bf16_f32 v129, v18, v19
    v_cvt_pk_bf16_f32 v130, v20, v21
    v_cvt_pk_bf16_f32 v131, v22, v23
    v_cvt_pk_bf16_f32 v132, v24, v25
    v_cvt_pk_bf16_f32 v133, v26, v27
    v_cvt_pk_bf16_f32 v134, v28, v29
    v_cvt_pk_bf16_f32 v135, v30, v31
    s_mov_b32 exec_lo, 0
    v_mov_b64 v[134:135], s[74:75]
    s_mov_b64 exec, -1
    buffer_store_dwordx4 v[128:131], v1, s[40:43], s21 offen offset:0 sc1
    buffer_store_dwordx4 v[132:135], v1, s[40:43], s21 offen offset:1024 sc1
    s_cmp_lt_u32 s64, 15
    s_cselect_b64 s[74:75], 0, s[24:25]
    s_cbranch_scc0 L_nosc1
    v_pk_mul_f32 v[32:33], v[32:33], s[34:35]
    v_pk_mul_f32 v[34:35], v[34:35], s[34:35]
    v_pk_mul_f32 v[36:37], v[36:37], s[34:35]
    v_pk_mul_f32 v[38:39], v[38:39], s[34:35]
    v_pk_mul_f32 v[40:41], v[40:41], s[34:35]
    v_pk_mul_f32 v[42:43], v[42:43], s[34:35]
    v_pk_mul_f32 v[44:45], v[44:45], s[34:35]
    v_pk_mul_f32 v[46:47], v[46:47], s[34:35]
L_nosc1:
    v_cvt_pk_bf16_f32 v136, v32, v33
    v_cvt_pk_bf16_f32 v137, v34, v35
    v_cvt_pk_bf16_f32 v138, v36, v37
    v_cvt_pk_bf16_f32 v139, v38, v39
    v_cvt_pk_bf16_f32 v140, v40, v41
    v_cvt_pk_bf16_f32 v141, v42, v43
    v_cvt_pk_bf16_f32 v142, v44, v45
    v_cvt_pk_bf16_f32 v143, v46, v47
    s_mov_b32 exec_lo, 0
    v_mov_b64 v[142:143], s[74:75]
    s_mov_b64 exec, -1
    buffer_store_dwordx4 v[136:139], v1, s[40:43], s22 offen offset:0 sc1
    buffer_store_dwordx4 v[140:143], v1, s[40:43], s22 offen offset:1024 sc1
    s_cmp_lt_u32 s64, 14
    s_cselect_b64 s[74:75], 0, s[24:25]
    s_cbranch_scc0 L_nosc2
    v_pk_mul_f32 v[48:49], v[48:49], s[34:35]
    v_pk_mul_f32 v[50:51], v[50:51], s[34:35]
    v_pk_mul_f32 v[52:53], v[52:53], s[34:35]
    v_pk_mul_f32 v[54:55], v[54:55], s[34:35]
    v_pk_mul_f32 v[56:57], v[56:57], s[34:35]
    v_pk_mul_f32 v[58:59], v[58:59], s[34:35]
    v_pk_mul_f32 v[60:61], v[60:61], s[34:35]
    v_pk_mul_f32 v[62:63], v[62:63], s[34:35]
L_nosc2:
    v_cvt_pk_bf16_f32 v144, v48, v49
    v_cvt_pk_bf16_f32 v145, v50, v51
    v_cvt_pk_bf16_f32 v146, v52, v53
    v_cvt_pk_bf16_f32 v147, v54, v55
    v_cvt_pk_bf16_f32 v148, v56, v57
    v_cvt_pk_bf16_f32 v149, v58, v59
    v_cvt_pk_bf16_f32 v150, v60, v61
    v_cvt_pk_bf16_f32 v151, v62, v63
    s_mov_b32 exec_lo, 0
    v_mov_b64 v[150:151], s[74:75]
    s_mov_b64 exec, -1
    buffer_store_dwordx4 v[144:147], v1, s[40:43], s23 offen offset:0 sc1
    buffer_store_dwordx4 v[148:151], v1, s[40:43], s23 offen offset:1024 sc1
    s_branch L_conv
L_gemm1:
    v_mfma_f32_32x32x16_bf16 v[48:63], v[80:83], v[92:95], v[48:63]
    s_barrier
    v_mfma_f32_32x32x16_bf16 v[16:31], v[100:103], v[96:99], v[16:31]
    ds_read_b128 v[64:67], v9
    ds_read_b64_tr_b16 v[68:69], v13 offset:0
    ds_read_b64_tr_b16 v[70:71], v13 offset:768
    v_mfma_f32_32x32x16_bf16 v[32:47], v[104:107], v[96:99], v[32:47]
    ds_read_b64_tr_b16 v[72:73], v13 offset:56
    ds_read_b64_tr_b16 v[74:75], v13 offset:824
    ds_read_b64_tr_b16 v[76:77], v13 offset:112
    v_mfma_f32_32x32x16_bf16 v[48:63], v[96:99], v[108:111], v[48:63]
    ds_read_b64_tr_b16 v[78:79], v13 offset:880
    ds_read_b128 v[80:83], v10
    ds_read_b64_tr_b16 v[84:85], v13 offset:3072
    v_mfma_f32_32x32x16_bf16 v[16:31], v[116:119], v[112:115], v[16:31]
    ds_read_b64_tr_b16 v[86:87], v13 offset:3840
    ds_read_b64_tr_b16 v[88:89], v13 offset:3128
    ds_read_b64_tr_b16 v[90:91], v13 offset:3896
    v_mfma_f32_32x32x16_bf16 v[32:47], v[120:123], v[112:115], v[32:47]
    ds_read_b64_tr_b16 v[92:93], v13 offset:3184
    ds_read_b64_tr_b16 v[94:95], v13 offset:3952
    ds_read_b128 v[96:99], v11
    v_mfma_f32_32x32x16_bf16 v[48:63], v[112:115], v[124:127], v[48:63]
    ds_read_b64_tr_b16 v[100:101], v13 offset:6144
    ds_read_b64_tr_b16 v[102:103], v13 offset:6912
    ds_read_b64_tr_b16 v[104:105], v13 offset:6200
    s_waitcnt lgkmcnt(11)
    v_mfma_f32_32x32x16_bf16 v[16:31], v[68:71], v[64:67], v[16:31]
    ds_read_b64_tr_b16 v[106:107], v13 offset:6968
    ds_read_b64_tr_b16 v[108:109], v13 offset:6256
    ds_read_b64_tr_b16 v[110:111], v13 offset:7024
    v_mfma_f32_32x32x16_bf16 v[32:47], v[72:75], v[64:67], v[32:47]
    ds_read_b128 v[112:115], v12
    ds_read_b64_tr_b16 v[116:117], v13 offset:9216
    ds_read_b64_tr_b16 v[118:119], v13 offset:9984
    v_mfma_f32_32x32x16_bf16 v[48:63], v[64:67], v[76:79], v[48:63]
    ds_read_b64_tr_b16 v[120:121], v13 offset:9272
    ds_read_b64_tr_b16 v[122:123], v13 offset:10040
    ds_read_b64_tr_b16 v[124:125], v13 offset:9328
    s_waitcnt lgkmcnt(13)
    v_mfma_f32_32x32x16_bf16 v[16:31], v[84:87], v[80:83], v[16:31]
    ds_read_b64_tr_b16 v[126:127], v13 offset:10096
    s_cmp_eq_u32 s65, 1
    s_movk_i32 s58, 12288
    s_cselect_b32 s58, 4294856704, s58
    s_add_u32 s65, s65, 1
    s_and_b32 s57, s65, 3
    s_lshl_b32 s57, s57, 12
    v_mfma_f32_32x32x16_bf16 v[32:47], v[88:91], v[80:83], v[32:47]
    v_add_u32 v13, s58, v13
    v_xor_b32 v9, s57, v14
    v_xor_b32 v10, 32, v9
    v_xor_b32 v11, 64, v9
    v_xor_b32 v12, 0x60, v9
    s_cmp_lt_u32 s65, 7
    s_waitcnt vmcnt(0) lgkmcnt(0)
    s_cbranch_scc1 L_gemm1
    v_mfma_f32_32x32x16_bf16 v[16:31], v[100:103], v[96:99], v[16:31]
    v_mfma_f32_32x32x16_bf16 v[48:63], v[80:83], v[92:95], v[48:63]
    v_mfma_f32_32x32x16_bf16 v[16:31], v[116:119], v[112:115], v[16:31]
    v_mfma_f32_32x32x16_bf16 v[32:47], v[104:107], v[96:99], v[32:47]
    v_mfma_f32_32x32x16_bf16 v[48:63], v[96:99], v[108:111], v[48:63]
    v_mfma_f32_32x32x16_bf16 v[32:47], v[120:123], v[112:115], v[32:47]
    v_mfma_f32_32x32x16_bf16 v[48:63], v[112:115], v[124:127], v[48:63]
    s_nop 7
    v_cvt_pk_bf16_f32 v128, v16, v17
    v_cvt_pk_bf16_f32 v129, v18, v19
    v_cvt_pk_bf16_f32 v130, v20, v21
    v_cvt_pk_bf16_f32 v131, v22, v23
    v_cvt_pk_bf16_f32 v132, v24, v25
    v_cvt_pk_bf16_f32 v133, v26, v27
    v_cvt_pk_bf16_f32 v134, v28, v29
    v_cvt_pk_bf16_f32 v135, v30, v31
    s_mov_b32 exec_lo, 0
    v_mov_b64 v[134:135], s[24:25]
    s_mov_b64 exec, -1
    buffer_store_dwordx4 v[128:131], v1, s[40:43], s21 offen offset:0 sc1
    buffer_store_dwordx4 v[132:135], v1, s[40:43], s21 offen offset:1024 sc1
    v_cvt_pk_bf16_f32 v136, v32, v33
    v_cvt_pk_bf16_f32 v137, v34, v35
    v_cvt_pk_bf16_f32 v138, v36, v37
    v_cvt_pk_bf16_f32 v139, v38, v39
    v_cvt_pk_bf16_f32 v140, v40, v41
    v_cvt_pk_bf16_f32 v141, v42, v43
    v_cvt_pk_bf16_f32 v142, v44, v45
    v_cvt_pk_bf16_f32 v143, v46, v47
    s_mov_b32 exec_lo, 0
    v_mov_b64 v[142:143], s[24:25]
    s_mov_b64 exec, -1
    buffer_store_dwordx4 v[136:139], v1, s[40:43], s22 offen offset:0 sc1
    buffer_store_dwordx4 v[140:143], v1, s[40:43], s22 offen offset:1024 sc1
    v_cvt_pk_bf16_f32 v144, v48, v49
    v_cvt_pk_bf16_f32 v145, v50, v51
    v_cvt_pk_bf16_f32 v146, v52, v53
    v_cvt_pk_bf16_f32 v147, v54, v55
    v_cvt_pk_bf16_f32 v148, v56, v57
    v_cvt_pk_bf16_f32 v149, v58, v59
    v_cvt_pk_bf16_f32 v150, v60, v61
    v_cvt_pk_bf16_f32 v151, v62, v63
    s_mov_b64 exec, s[74:75]
    v_mov_b64 v[144:145], s[76:77]
    v_mov_b64 v[146:147], s[76:77]
    v_mov_b64 v[148:149], s[76:77]
    v_mov_b64 v[150:151], s[76:77]
    s_mov_b64 exec, -1
    buffer_store_dwordx4 v[144:147], v1, s[40:43], s23 offen offset:2048 sc1
    buffer_store_dwordx4 v[148:151], v1, s[40:43], s23 offen offset:3072 sc1
    s_branch L_conv
L_gemm2:
    v_mfma_f32_32x32x16_bf16 v[48:63], v[80:83], v[92:95], v[48:63]
    s_barrier
    v_mfma_f32_32x32x16_bf16 v[16:31], v[96:99], v[100:103], v[16:31]
    ds_read_b128 v[64:67], v9
    ds_read_b64_tr_b16 v[68:69], v13 offset:0
    ds_read_b64_tr_b16 v[70:71], v13 offset:768
    v_mfma_f32_32x32x16_bf16 v[32:47], v[96:99], v[104:107], v[32:47]
    ds_read_b64_tr_b16 v[72:73], v13 offset:56
    ds_read_b64_tr_b16 v[74:75], v13 offset:824
    ds_read_b64_tr_b16 v[76:77], v13 offset:112
    v_mfma_f32_32x32x16_bf16 v[48:63], v[96:99], v[108:111], v[48:63]
    ds_read_b64_tr_b16 v[78:79], v13 offset:880
    ds_read_b128 v[80:83], v10
    ds_read_b64_tr_b16 v[84:85], v13 offset:3072
    v_mfma_f32_32x32x16_bf16 v[16:31], v[112:115], v[116:119], v[16:31]
    ds_read_b64_tr_b16 v[86:87], v13 offset:3840
    ds_read_b64_tr_b16 v[88:89], v13 offset:3128
    ds_read_b64_tr_b16 v[90:91], v13 offset:3896
    v_mfma_f32_32x32x16_bf16 v[32:47], v[112:115], v[120:123], v[32:47]
    ds_read_b64_tr_b16 v[92:93], v13 offset:3184
    ds_read_b64_tr_b16 v[94:95], v13 offset:3952
    ds_read_b128 v[96:99], v11
    v_mfma_f32_32x32x16_bf16 v[48:63], v[112:115], v[124:127], v[48:63]
    ds_read_b64_tr_b16 v[100:101], v13 offset:6144
    ds_read_b64_tr_b16 v[102:103], v13 offset:6912
    ds_read_b64_tr_b16 v[104:105], v13 offset:6200
    s_waitcnt lgkmcnt(11)
    v_mfma_f32_32x32x16_bf16 v[16:31], v[64:67], v[68:71], v[16:31]
    ds_read_b64_tr_b16 v[106:107], v13 offset:6968
    ds_read_b64_tr_b16 v[108:109], v13 offset:6256
    ds_read_b64_tr_b16 v[110:111], v13 offset:7024
    v_mfma_f32_32x32x16_bf16 v[32:47], v[64:67], v[72:75], v[32:47]
    ds_read_b128 v[112:115], v12
    ds_read_b64_tr_b16 v[116:117], v13 offset:9216
    ds_read_b64_tr_b16 v[118:119], v13 offset:9984
    v_mfma_f32_32x32x16_bf16 v[48:63], v[64:67], v[76:79], v[48:63]
    ds_read_b64_tr_b16 v[120:121], v13 offset:9272
    ds_read_b64_tr_b16 v[122:123], v13 offset:10040
    ds_read_b64_tr_b16 v[124:125], v13 offset:9328
    s_waitcnt lgkmcnt(13)
    v_mfma_f32_32x32x16_bf16 v[16:31], v[80:83], v[84:87], v[16:31]
    ds_read_b64_tr_b16 v[126:127], v13 offset:10096
    s_cmp_eq_u32 s65, 1
    s_movk_i32 s58, 12288
    s_cselect_b32 s58, 4294856704, s58
    s_add_u32 s65, s65, 1
    s_and_b32 s57, s65, 3
    s_lshl_b32 s57, s57, 12
    v_mfma_f32_32x32x16_bf16 v[32:47], v[80:83], v[88:91], v[32:47]
    v_add_u32 v13, s58, v13
    v_xor_b32 v9, s57, v14
    v_xor_b32 v10, 32, v9
    v_xor_b32 v11, 64, v9
    v_xor_b32 v12, 0x60, v9
    s_cmp_lt_u32 s65, 7
    s_waitcnt vmcnt(0) lgkmcnt(0)
    s_cbranch_scc1 L_gemm2
    v_mfma_f32_32x32x16_bf16 v[16:31], v[96:99], v[100:103], v[16:31]
    v_mfma_f32_32x32x16_bf16 v[48:63], v[80:83], v[92:95], v[48:63]
    v_mfma_f32_32x32x16_bf16 v[16:31], v[112:115], v[116:119], v[16:31]
    v_mfma_f32_32x32x16_bf16 v[32:47], v[96:99], v[104:107], v[32:47]
    v_mfma_f32_32x32x16_bf16 v[48:63], v[96:99], v[108:111], v[48:63]
    v_mfma_f32_32x32x16_bf16 v[32:47], v[112:115], v[120:123], v[32:47]
    v_mfma_f32_32x32x16_bf16 v[48:63], v[112:115], v[124:127], v[48:63]
    s_nop 7
    v_cvt_pk_bf16_f32 v128, v16, v17
    v_cvt_pk_bf16_f32 v129, v18, v19
    v_cvt_pk_bf16_f32 v130, v20, v21
    v_cvt_pk_bf16_f32 v131, v22, v23
    v_cvt_pk_bf16_f32 v132, v24, v25
    v_cvt_pk_bf16_f32 v133, v26, v27
    v_cvt_pk_bf16_f32 v134, v28, v29
    v_cvt_pk_bf16_f32 v135, v30, v31
    s_mov_b64 exec, s[74:75]
    v_mov_b64 v[128:129], s[76:77]
    v_mov_b64 v[130:131], s[76:77]
    v_mov_b64 v[132:133], s[76:77]
    v_mov_b64 v[134:135], s[76:77]
    s_mov_b64 exec, -1
    buffer_store_dwordx4 v[128:131], v1, s[40:43], s21 offen offset:2048 sc1
    buffer_store_dwordx4 v[132:135], v1, s[40:43], s21 offen offset:3072 sc1
    v_cvt_pk_bf16_f32 v136, v32, v33
    v_cvt_pk_bf16_f32 v137, v34, v35
    v_cvt_pk_bf16_f32 v138, v36, v37
    v_cvt_pk_bf16_f32 v139, v38, v39
    v_cvt_pk_bf16_f32 v140, v40, v41
    v_cvt_pk_bf16_f32 v141, v42, v43
    v_cvt_pk_bf16_f32 v142, v44, v45
    v_cvt_pk_bf16_f32 v143, v46, v47
    s_mov_b64 exec, s[74:75]
    v_mov_b64 v[136:137], s[76:77]
    v_mov_b64 v[138:139], s[76:77]
    v_mov_b64 v[140:141], s[76:77]
    v_mov_b64 v[142:143], s[76:77]
    s_mov_b64 exec, -1
    buffer_store_dwordx4 v[136:139], v1, s[40:43], s22 offen offset:2048 sc1
    buffer_store_dwordx4 v[140:143], v1, s[40:43], s22 offen offset:3072 sc1
    v_cvt_pk_bf16_f32 v144, v48, v49
    v_cvt_pk_bf16_f32 v145, v50, v51
    v_cvt_pk_bf16_f32 v146, v52, v53
    v_cvt_pk_bf16_f32 v147, v54, v55
    v_cvt_pk_bf16_f32 v148, v56, v57
    v_cvt_pk_bf16_f32 v149, v58, v59
    v_cvt_pk_bf16_f32 v150, v60, v61
    v_cvt_pk_bf16_f32 v151, v62, v63
    s_mov_b64 exec, s[74:75]
    v_mov_b64 v[144:145], s[76:77]
    v_mov_b64 v[146:147], s[76:77]
    v_mov_b64 v[148:149], s[76:77]
    v_mov_b64 v[150:151], s[76:77]
    s_mov_b64 exec, -1
    buffer_store_dwordx4 v[144:147], v1, s[40:43], s23 offen offset:2048 sc1
    buffer_store_dwordx4 v[148:151], v1, s[40:43], s23 offen offset:3072 sc1
    s_branch L_conv
L_loader:
    s_mul_i32 s57, s48, 168
    s_and_b32 s57, s57, -16
    s_mul_i32 s59, s55, 43008
    s_add_u32 s57, s57, s59
    s_mul_i32 s68, s55, 3072
    v_add_u32 v128, 0, v0
    v_mul_u32_u24 v129, 43691, v128
    v_lshrrev_b32 v129, 19, v129
    v_mul_u32_u24 v131, 12, v129
    v_sub_u32 v128, v128, v131
    v_min_u32 v128, 10, v128
    v_mul_u32_u24 v129, 2688, v129
    v_lshl_add_u32 v128, v128, 4, v129
    v_add_u32 v6, s57, v128
    s_sub_u32 s57, s57, 1024
    v_add_u32 v128, 64, v0
    v_mul_u32_u24 v129, 43691, v128
    v_lshrrev_b32 v129, 19, v129
    v_mul_u32_u24 v131, 12, v129
    v_sub_u32 v128, v128, v131
    v_min_u32 v128, 10, v128
    v_mul_u32_u24 v129, 2688, v129
    v_lshl_add_u32 v128, v128, 4, v129
    v_add_u32 v7, s57, v128
    s_sub_u32 s57, s57, 1024
    v_add_u32 v128, 128, v0
    v_mul_u32_u24 v129, 43691, v128
    v_lshrrev_b32 v129, 19, v129
    v_mul_u32_u24 v131, 12, v129
    v_sub_u32 v128, v128, v131
    v_min_u32 v128, 10, v128
    v_mul_u32_u24 v129, 2688, v129
    v_lshl_add_u32 v128, v128, 4, v129
    v_add_u32 v8, s57, v128
    s_add_u32 m0, s68, 98304
    s_add_u32 s67, s65, 0
    s_cmp_ge_u32 s67, 7
    s_cselect_b32 s71, 7, 0
    s_sub_u32 s67, s67, s71
    s_mul_i32 s67, s67, 172032
    buffer_load_dwordx4 v6, s[8:11], s67 offen offset:0 lds
    s_and_b32 s59, s2, 7
    s_lshr_b32 s60, s2, 5
    s_lshl3_add_u32 s50, s59, s60
    s_bfe_u32 s51, s2, 0x20003
    v_and_b32 v129, 15, v0
    v_min_u32 v129, 13, v129
    s_lshl2_add_u32 s57, s51, s55
    s_mul_i32 s58, s57, 56
    s_mul_i32 s59, s50, 28672
    s_add_u32 s59, s59, s58
    v_mul_u32_u24 v210, 7168, v130
    v_lshl_add_u32 v132, v129, 2, v210
    buffer_load_dwordx4 v7, s[8:11], s67 offen offset:1024 lds
    v_add_u32 v211, s59, v132
    v_lshlrev_b32 v1, 4, v0
    s_sub_u32 s59, s2, 32
    s_cmp_lt_u32 s2, 224
    s_cselect_b32 s52, s2, s59
    s_load_dword s56, s[40:41], 0
    s_lshl_b32 s57, s52, 2
    s_load_dword s73, s[44:45], s57
    s_load_dwordx2 s[32:33], s[0:1], 56
    s_load_dwordx2 s[12:13], s[0:1], 16
    s_load_dwordx2 s[16:17], s[0:1], 24
    s_load_dwordx2 s[36:37], s[0:1], 72
    s_mov_b32 s14, 401408
    buffer_load_dwordx4 v8, s[8:11], s67 offen offset:2048 lds
    s_mov_b32 s15, 0x20000
    s_mov_b32 s18, 1835008
    s_mov_b32 s19, 0x20000
    s_mov_b32 s38, 3670016
    s_mov_b32 s39, 0x20000
    s_mov_b32 s42, 13631488
    s_mov_b32 s43, 0x20000
    v_add_u32 v210, v210, v211
    v_lshlrev_b32 v133, 7, v129
    v_lshl_add_u32 v209, v130, 4, v133
    s_lshl2_add_u32 s61, s51, s55
    s_mul_i32 s58, s61, 1792
    s_add_u32 m0, s68, 110592
    s_add_u32 s67, s65, 1
    s_cmp_ge_u32 s67, 7
    s_cselect_b32 s71, 7, 0
    s_sub_u32 s67, s67, s71
    s_mul_i32 s67, s67, 172032
    buffer_load_dwordx4 v6, s[8:11], s67 offen offset:0 lds
    s_mul_i32 s60, s50, 28672
    s_add_u32 s31, s58, s60
    s_add_u32 s31, s31, 9437184
    s_and_b32 s59, s2, 7
    s_lshr_b32 s60, s2, 7
    s_lshl1_add_u32 s53, s59, s60
    s_bfe_u32 s54, s2, 0x40003
    s_mov_b32 s70, 0
    s_lshr_b32 s64, s47, 2
    s_mul_i32 s72, s64, 98304
    v_and_b32 v132, 3, v0
    v_sub_u32 v133, 3, v132
    buffer_load_dwordx4 v7, s[8:11], s67 offen offset:1024 lds
    v_mul_u32_u24 v133, 4160, v133
    v_and_b32 v134, 12, v0
    v_lshl_add_u32 v133, v134, 1, v133
    v_and_b32 v134, 0x30, v0
    v_sub_u32 v133, v133, v134
    s_lshl_b32 s57, s55, 7
    s_add_u32 s58, s57, s72
    s_add_u32 s58, s58, 56
    v_add_u32 v192, s58, v133
    v_and_b32 v139, 15, v0
    v_lshl_add_u32 v133, v139, 5, v134
    s_sub_u32 s58, s72, s57
    buffer_load_dwordx4 v8, s[8:11], s67 offen offset:2048 lds
    s_add_u32 s58, s58, 17056
    v_add_u32 v193, s58, v133
    v_lshrrev_b32 v131, 5, v0
    v_lshlrev_b32 v133, 7, v131
    v_xor_b32 v133, v133, v1
    s_lshl_b32 s57, s55, 13
    s_add_u32 s57, s57, s72
    v_add_u32 v194, s57, v133
    v_bfe_u32 v135, v0, 2, 1
    v_mul_u32_u24 v136, 98304, v135
    v_lshrrev_b32 v137, 3, v0
    v_lshl_add_u32 v138, v137, 2, v132
    s_add_u32 m0, s69, 4096
    s_add_u32 s66, s65, 1
    s_cmp_ge_u32 s66, 7
    s_cselect_b32 s71, 7, 0
    s_sub_u32 s66, s66, s71
    s_mul_i32 s66, s66, 128
    buffer_load_dwordx4 v2, s[4:7], s66 offen offset:0 lds
    v_lshrrev_b32 v133, 1, v138
    v_and_b32 v134, 1, v0
    v_mul_u32_u24 v134, 40, v134
    v_xor_b32 v133, v133, v134
    v_lshl_add_u32 v133, v133, 4, v136
    s_lshl_b32 s57, s47, 10
    v_add_u32 v195, s57, v133
    v_lshl_add_u32 v133, v138, 4, v136
    s_lshl_b32 s57, s47, 9
    s_add_u32 s57, s57, 17152
    v_add_u32 v196, s57, v133
    v_mul_u32_u24 v133, 28672, v137
    buffer_load_dwordx4 v3, s[4:7], s66 offen offset:1024 lds
    v_and_b32 v134, 7, v0
    v_lshl_add_u32 v197, v134, 4, v133
    v_lshlrev_b32 v134, 2, v134
    v_add_u32 v205, 102272, v134
    s_mul_i32 s57, s47, 229376
    s_lshl_b32 s58, s52, 7
    s_add_u32 s57, s57, s58
    s_add_u32 s26, s57, 9437184
    s_lshl_b32 s78, s53, 18
    s_add_u32 s78, s78, 3145728
    s_lshl_b32 s28, s47, 12
    s_add_u32 s3, s78, s28
    buffer_load_dwordx4 v4, s[4:7], s66 offen offset:2048 lds
    s_min_u32 s57, s47, 6
    s_lshl_b32 s79, s57, 10
    s_lshl_b32 s58, s57, 6
    v_add_u32 v133, s58, v0
    v_mul_u32_u24 v134, 4682, v133
    v_lshrrev_b32 v134, 16, v134
    v_mul_u32_u24 v136, 14, v134
    v_sub_u32 v133, v133, v136
    v_bfe_u32 v136, v134, 1, 2
    v_and_b32 v138, 1, v134
    v_lshl_add_u32 v136, v138, 2, v136
    v_and_or_b32 v134, v134, 24, v136
    buffer_load_dwordx4 v5, s[4:7], s66 offen offset:3072 lds
    v_mul_u32_u24 v134, 896, v134
    v_lshl_add_u32 v133, v133, 4, v134
    s_mul_i32 s58, s51, 224
    v_add_u32 v202, s58, v133
    s_and_b32 s57, s47, 1
    s_lshl1_add_u32 s57, s64, s57
    s_lshl_b32 s57, s57, 13
    s_add_u32 s57, s57, 32768
    v_add_u32 v199, s57, v1
    v_add_u32 v200, 0x10000, v199
    s_lshl_b32 s57, s55, 11
    s_add_u32 s57, s57, 131072
    s_add_u32 m0, s68, 0
    s_add_u32 s67, s65, 2
    s_cmp_ge_u32 s67, 7
    s_cselect_b32 s71, 7, 0
    s_sub_u32 s67, s67, s71
    s_mul_i32 s67, s67, 172032
    buffer_load_dwordx4 v6, s[8:11], s67 offen offset:0 lds
    v_add_u32 v201, s57, v1
    s_lshl_b32 s57, s55, 12
    s_add_u32 s57, s57, 114688
    v_add_u32 v203, s57, v1
    s_lshl_b32 s58, s47, 2
    s_add_u32 s58, s58, 102272
    v_mov_b32 v204, s58
    s_lshl_b32 s60, s54, 2
    s_add_u32 s60, s60, s55
    s_lshl_b32 s57, s60, 4
    s_add_u32 s57, s57, s53
    s_lshl_b32 s57, s57, 11
    buffer_load_dwordx4 v7, s[8:11], s67 offen offset:1024 lds
    s_add_u32 s27, s57, 11534336
    s_lshl4_add_u32 s57, s53, s54
    s_lshl3_add_u32 s57, s57, s47
    s_lshl_b32 s57, s57, 10
    s_add_u32 s30, s57, 1048576
    v_cmp_eq_u32 vcc, 0, v135
    s_waitcnt lgkmcnt(0)
    s_mul_i32 s46, s56, 1664525
    s_add_u32 s46, s46, 1013904223
    s_lshl_b32 s57, s73, 16
    s_and_b32 s58, s73, 0xffff0000
    v_mov_b32 v133, s57
    buffer_load_dwordx4 v8, s[8:11], s67 offen offset:2048 lds
    v_mov_b32 v134, s58
    v_cndmask_b32 v198, v134, v133, vcc
    v_mov_b32 v15, s46
    s_lshl_b32 s57, s64, 10
    s_add_u32 s44, s27, s57
    s_and_b32 s57, s47, 6
    s_add_u32 s57, s57, s47
    s_lshl_b32 s45, s57, 11
    v_mov_b32 v133, 65520
    v_mov_b32 v134, 0
    ds_write_b32 v133, v134
    v_min_u32 v133, 2, v130
    s_add_u32 m0, s69, 8192
    s_add_u32 s66, s65, 2
    s_cmp_ge_u32 s66, 7
    s_cselect_b32 s71, 7, 0
    s_sub_u32 s66, s66, s71
    s_mul_i32 s66, s66, 128
    buffer_load_dwordx4 v2, s[4:7], s66 offen offset:0 lds
    v_lshl_add_u32 v133, v133, 4, s53
    v_mul_u32_u24 v133, 21846, v133
    v_lshrrev_b32 v133, 16, v133
    v_mov_b32 v134, s54
    v_cmp_gt_u32 vcc, 16, v0
    s_lshl_b32 s57, s51, 6
    s_add_u32 s57, s57, s50
    s_lshl_b32 s57, s57, 4
    s_add_u32 s20, s57, 262144
    v_cndmask_b32 v134, v139, v134, vcc
    v_lshl_add_u32 v133, v133, 4, v134
    v_lshlrev_b32 v133, 4, v133
    buffer_load_dwordx4 v3, s[4:7], s66 offen offset:1024 lds
    v_add_u32 v208, 393216, v133
    s_mul_i32 s57, s52, 1171
    s_lshr_b32 s57, s57, 16
    s_lshl2_add_u32 s57, s57, s55
    s_lshl_b32 s57, s57, 8
    s_add_u32 s57, s57, 262144
    v_lshl_add_u32 v206, v139, 4, s57
    v_lshrrev_b32 v133, 2, v0
    v_mul_u32_u24 v133, 28672, v133
    v_lshl_add_u32 v207, v132, 4, v133
    s_mul_i32 s57, s55, 458752
    s_lshl_b32 s58, s52, 7
    buffer_load_dwordx4 v4, s[4:7], s66 offen offset:2048 lds
    s_add_u32 s57, s57, s58
    s_add_u32 s29, s57, 7340032
    v_bfe_u32 v138, v0, 1, 2
    v_mul_u32_u24 v138, 4160, v138
    v_and_b32 v139, 1, v0
    v_lshl_add_u32 v138, v139, 4, v138
    v_add_u32 v139, 16640, v1
    v_cmp_gt_u32 vcc, 32, v0
    v_mov_b64 v[140:141], 0
    v_mov_b64 v[142:143], 0
    v_cndmask_b32 v138, v138, v139, vcc
    v_add_u32 v139, 98304, v138
    buffer_load_dwordx4 v5, s[4:7], s66 offen offset:3072 lds
    s_mov_b32 s34, 1835008
    s_mov_b32 s35, 0x20000
    s_lshl_b32 s60, s52, 13
    s_lshl_b32 s61, s55, 10
    s_add_u32 s60, s60, s61
    v_add_u32 v11, s60, v1
    v_add_u32 v10, s61, v1
    v_subrev_u32 v12, 8, v11
    v_cmp_eq_u32 vcc, 0, v10
    v_mov_b32 v136, 0xffffe000
    s_movk_i32 s64, 4096
    v_cndmask_b32 v12, v12, v136, vcc
    s_waitcnt vmcnt(14)
    s_barrier
    s_add_u32 m0, s68, 12288
    s_add_u32 s67, s65, 3
    s_cmp_ge_u32 s67, 7
    s_cselect_b32 s71, 7, 0
    s_sub_u32 s67, s67, s71
    s_mul_i32 s67, s67, 172032
    buffer_load_dwordx4 v6, s[8:11], s67 offen offset:0 lds
    buffer_load_dwordx4 v7, s[8:11], s67 offen offset:1024 lds
    buffer_load_dwordx4 v8, s[8:11], s67 offen offset:2048 lds
    s_add_u32 m0, s69, 12288
    s_add_u32 s66, s65, 3
    s_cmp_ge_u32 s66, 7
    s_cselect_b32 s71, 7, 0
    s_sub_u32 s66, s66, s71
    s_mul_i32 s66, s66, 128
    buffer_load_dwordx4 v2, s[4:7], s66 offen offset:0 lds
    buffer_load_dwordx4 v3, s[4:7], s66 offen offset:1024 lds
    buffer_load_dwordx4 v4, s[4:7], s66 offen offset:2048 lds
    buffer_load_dwordx4 v5, s[4:7], s66 offen offset:3072 lds
    s_waitcnt vmcnt(14)
    s_barrier
    s_cmp_lg_u32 s47, 4
    s_cbranch_scc1 L_nsa
    s_mov_b64 exec, 1
    buffer_store_dword v15, v1, s[40:43], s20 offen sc1
    s_mov_b64 exec, -1
L_nsa:
    buffer_load_dwordx2 v[112:113], v12, s[32:35], 0 offen
    buffer_load_dwordx4 v[114:117], v11, s[32:35], 0 offen
    buffer_load_dwordx2 v[120:121], v12, s[32:35], s64 offen
    buffer_load_dwordx4 v[122:125], v11, s[32:35], s64 offen
    s_add_u32 m0, s68, 24576
    s_add_u32 s67, s65, 4
    s_cmp_ge_u32 s67, 7
    s_cselect_b32 s71, 7, 0
    s_sub_u32 s67, s67, s71
    s_mul_i32 s67, s67, 172032
    buffer_load_dwordx4 v6, s[8:11], s67 offen offset:0 lds
    buffer_load_dwordx4 v7, s[8:11], s67 offen offset:1024 lds
    s_waitcnt vmcnt(13)
    s_barrier
    buffer_load_dwordx4 v8, s[8:11], s67 offen offset:2048 lds
    s_add_u32 m0, s69, 0
    s_add_u32 s66, s65, 4
    s_cmp_ge_u32 s66, 7
    s_cselect_b32 s71, 7, 0
    s_sub_u32 s66, s66, s71
    s_mul_i32 s66, s66, 128
    buffer_load_dwordx4 v2, s[4:7], s66 offen offset:0 lds
    buffer_load_dwordx4 v3, s[4:7], s66 offen offset:1024 lds
    buffer_load_dwordx4 v4, s[4:7], s66 offen offset:2048 lds
    buffer_load_dwordx4 v5, s[4:7], s66 offen offset:3072 lds
    s_add_u32 m0, s68, 36864
    s_add_u32 s67, s65, 5
    s_cmp_ge_u32 s67, 7
    s_cselect_b32 s71, 7, 0
    s_sub_u32 s67, s67, s71
    s_mul_i32 s67, s67, 172032
    buffer_load_dwordx4 v6, s[8:11], s67 offen offset:0 lds
    s_waitcnt vmcnt(12)
    s_barrier
    buffer_load_dwordx4 v7, s[8:11], s67 offen offset:1024 lds
    buffer_load_dwordx4 v8, s[8:11], s67 offen offset:2048 lds
    s_add_u32 m0, s69, 4096
    s_add_u32 s66, s65, 5
    s_cmp_ge_u32 s66, 7
    s_cselect_b32 s71, 7, 0
    s_sub_u32 s66, s66, s71
    s_mul_i32 s66, s66, 128
    buffer_load_dwordx4 v2, s[4:7], s66 offen offset:0 lds
    buffer_load_dwordx4 v3, s[4:7], s66 offen offset:1024 lds
    buffer_load_dwordx4 v4, s[4:7], s66 offen offset:2048 lds
    buffer_load_dwordx4 v5, s[4:7], s66 offen offset:3072 lds
    s_add_u32 m0, s68, 49152
    s_add_u32 s67, s65, 6
    s_cmp_ge_u32 s67, 7
    s_cselect_b32 s71, 7, 0
    s_sub_u32 s67, s67, s71
    s_mul_i32 s67, s67, 172032
    buffer_load_dwordx4 v6, s[8:11], s67 offen offset:0 lds
    buffer_load_dwordx4 v7, s[8:11], s67 offen offset:1024 lds
    s_waitcnt vmcnt(9)
    s_barrier
    buffer_load_dwordx4 v8, s[8:11], s67 offen offset:2048 lds
    s_add_u32 m0, s69, 8192
    s_add_u32 s66, s65, 6
    s_cmp_ge_u32 s66, 7
    s_cselect_b32 s71, 7, 0
    s_sub_u32 s66, s66, s71
    s_mul_i32 s66, s66, 128
    buffer_load_dwordx4 v2, s[4:7], s66 offen offset:0 lds
    buffer_load_dwordx4 v3, s[4:7], s66 offen offset:1024 lds
    buffer_load_dwordx4 v4, s[4:7], s66 offen offset:2048 lds
    buffer_load_dwordx4 v5, s[4:7], s66 offen offset:3072 lds
    s_waitcnt vmcnt(7)
    s_barrier
    buffer_load_dword v144, v206, s[40:43], 0 offen sc1
    v_add_u32 v135, 98336, v10
    v_alignbit_b32 v52, v122, v121, 16
    v_alignbit_b32 v53, v123, v122, 16
    v_alignbit_b32 v54, v124, v123, 16
    v_alignbit_b32 v55, v125, v124, 16
    v_mov_b32 v56, v121
    v_mov_b32 v57, v122
    v_mov_b32 v58, v123
    v_mov_b32 v59, v124
    v_alignbit_b32 v60, v121, v120, 16
    v_alignbit_b32 v61, v122, v121, 16
    v_alignbit_b32 v62, v123, v122, 16
    v_alignbit_b32 v63, v124, v123, 16
    ds_write_b128 v135, v[122:125]
    ds_write_b128 v135, v[52:55] offset:4160
    ds_write_b128 v135, v[56:59] offset:8320
    ds_write_b128 v135, v[60:63] offset:12480
    ds_write_b128 v139, v[140:143]
    s_waitcnt vmcnt(1)
    s_barrier
    s_waitcnt vmcnt(0)
    v_cmp_ne_u32 vcc, s46, v144
    s_nop 0
    s_cbranch_vccz L_uok
    s_mov_b32 s71, 65536
L_poll0:
    buffer_load_dword v144, v206, s[40:43], 0 offen sc1
    s_waitcnt vmcnt(0)
    v_cmp_ne_u32 vcc, s46, v144
    s_nop 0
    s_cbranch_vccz L_pollok0
    s_sub_u32 s71, s71, 1
    s_cbranch_scc0 L_poll0
L_pollok0:
L_uok:
    s_lshl_b32 s59, s55, 10
    s_add_u32 m0, s59, 17152
    s_add_u32 s58, s29, 64
    buffer_load_dwordx4 v207, s[40:43], s29 offen sc1 lds
    s_add_u32 m0, s59, 115456
    s_nop 0
    buffer_load_dwordx4 v207, s[40:43], s58 offen sc1 lds
    v_add_u32 v134, 32, v10
    v_alignbit_b32 v40, v114, v113, 16
    v_alignbit_b32 v41, v115, v114, 16
    v_alignbit_b32 v42, v116, v115, 16
    v_alignbit_b32 v43, v117, v116, 16
    v_mov_b32 v44, v113
    v_mov_b32 v45, v114
    v_mov_b32 v46, v115
    v_mov_b32 v47, v116
    v_alignbit_b32 v48, v113, v112, 16
    v_alignbit_b32 v49, v114, v113, 16
    v_alignbit_b32 v50, v115, v114, 16
    v_alignbit_b32 v51, v116, v115, 16
    ds_write_b128 v134, v[114:117]
    ds_write_b128 v134, v[40:43] offset:4160
    ds_write_b128 v134, v[44:47] offset:8320
    ds_write_b128 v134, v[48:51] offset:12480
    ds_write_b128 v138, v[140:143]
    s_setprio 1
    s_waitcnt vmcnt(0) lgkmcnt(0)
L_conv:
    s_barrier
    ds_read_b64 v[64:65], v192 offset:0
    ds_read_b64 v[66:67], v192 offset:8
    ds_read_b128 v[128:131], v193 offset:64
    ds_read_b64 v[68:69], v192 offset:512
    ds_read_b64 v[70:71], v192 offset:520
    ds_read_b128 v[132:135], v193 offset:576
    ds_read_b64 v[72:73], v192 offset:1024
    ds_read_b64 v[74:75], v192 offset:1032
    ds_read_b128 v[136:139], v193 offset:1088
    ds_read_b64 v[76:77], v192 offset:1536
    ds_read_b64 v[78:79], v192 offset:1544
    ds_read_b128 v[140:143], v193 offset:1600
    ds_read_b64 v[80:81], v192 offset:2048
    ds_read_b64 v[82:83], v192 offset:2056
    ds_read_b128 v[144:147], v193 offset:2112
    s_waitcnt lgkmcnt(12)
    v_mfma_f32_16x16x32_bf16 v[16:19], v[64:67], v[128:131], 0
    ds_read_b64 v[84:85], v192 offset:2560
    s_waitcnt lgkmcnt(10)
    v_mfma_f32_16x16x32_bf16 v[20:23], v[64:67], v[132:135], 0
    ds_read_b64 v[86:87], v192 offset:2568
    v_mfma_f32_16x16x32_bf16 v[24:27], v[68:71], v[132:135], 0
    ds_read_b128 v[148:151], v193 offset:2624
    v_mfma_f32_16x16x32_bf16 v[20:23], v[68:71], v[128:131], v[20:23]
    ds_read_b64 v[88:89], v192 offset:3072
    s_waitcnt lgkmcnt(10)
    v_mfma_f32_16x16x32_bf16 v[24:27], v[64:67], v[136:139], v[24:27]
    ds_read_b64 v[90:91], v192 offset:3080
    v_mfma_f32_16x16x32_bf16 v[28:31], v[68:71], v[136:139], 0
    ds_read_b128 v[152:155], v193 offset:3136
    v_mfma_f32_16x16x32_bf16 v[24:27], v[72:75], v[128:131], v[24:27]
    ds_read_b64 v[92:93], v192 offset:3584
    v_mfma_f32_16x16x32_bf16 v[28:31], v[72:75], v[132:135], v[28:31]
    ds_read_b64 v[94:95], v192 offset:3592
    v_mfma_f32_16x16x32_bf16 v[32:35], v[72:75], v[136:139], 0
    ds_read_b128 v[156:159], v193 offset:3648
    s_waitcnt lgkmcnt(12)
    v_mfma_f32_16x16x32_bf16 v[28:31], v[64:67], v[140:143], v[28:31]
    ds_read_b64 v[96:97], v192 offset:64
    v_mfma_f32_16x16x32_bf16 v[32:35], v[68:71], v[140:143], v[32:35]
    ds_read_b64 v[98:99], v192 offset:72
    v_mfma_f32_16x16x32_bf16 v[36:39], v[72:75], v[140:143], 0
    ds_read_b128 v[160:163], v193 offset:0
    v_mfma_f32_16x16x32_bf16 v[28:31], v[76:79], v[128:131], v[28:31]
    ds_read_b64 v[100:101], v192 offset:576
    v_mfma_f32_16x16x32_bf16 v[32:35], v[76:79], v[132:135], v[32:35]
    ds_read_b64 v[102:103], v192 offset:584
    v_mfma_f32_16x16x32_bf16 v[36:39], v[76:79], v[136:139], v[36:39]
    ds_read_b128 v[164:167], v193 offset:512
    v_mfma_f32_16x16x32_bf16 v[40:43], v[76:79], v[140:143], 0
    ds_read_b64 v[104:105], v192 offset:1088
    s_waitcnt lgkmcnt(15)
    v_mfma_f32_16x16x32_bf16 v[32:35], v[64:67], v[144:147], v[32:35]
    ds_read_b64 v[106:107], v192 offset:1096
    v_mfma_f32_16x16x32_bf16 v[36:39], v[68:71], v[144:147], v[36:39]
    ds_read_b128 v[168:171], v193 offset:1024
    v_mfma_f32_16x16x32_bf16 v[40:43], v[72:75], v[144:147], v[40:43]
    ds_read_b64 v[108:109], v192 offset:1600
    v_mfma_f32_16x16x32_bf16 v[44:47], v[76:79], v[144:147], 0
    ds_read_b64 v[110:111], v192 offset:1608
    v_mfma_f32_16x16x32_bf16 v[32:35], v[80:83], v[128:131], v[32:35]
    ds_read_b128 v[172:175], v193 offset:1536
    v_mfma_f32_16x16x32_bf16 v[36:39], v[80:83], v[132:135], v[36:39]
    ds_read_b64 v[112:113], v192 offset:2112
    v_mfma_f32_16x16x32_bf16 v[40:43], v[80:83], v[136:139], v[40:43]
    ds_read_b64 v[114:115], v192 offset:2120
    v_mfma_f32_16x16x32_bf16 v[44:47], v[80:83], v[140:143], v[44:47]
    ds_read_b128 v[176:179], v193 offset:2048
    s_waitcnt lgkmcnt(15)
    v_mfma_f32_16x16x32_bf16 v[36:39], v[64:67], v[148:151], v[36:39]
    ds_read_b64 v[116:117], v192 offset:2624
    v_mfma_f32_16x16x32_bf16 v[40:43], v[68:71], v[148:151], v[40:43]
    ds_read_b64 v[118:119], v192 offset:2632
    v_mfma_f32_16x16x32_bf16 v[44:47], v[72:75], v[148:151], v[44:47]
    ds_read_b128 v[180:183], v193 offset:2560
    v_mfma_f32_16x16x32_bf16 v[36:39], v[84:87], v[128:131], v[36:39]
    ds_read_b64 v[120:121], v192 offset:3136
    v_mfma_f32_16x16x32_bf16 v[40:43], v[84:87], v[132:135], v[40:43]
    ds_read_b64 v[122:123], v192 offset:3144
    v_mfma_f32_16x16x32_bf16 v[44:47], v[84:87], v[136:139], v[44:47]
    ds_read_b128 v[184:187], v193 offset:3072
    v_mfma_f32_16x16x32_bf16 v[40:43], v[64:67], v[152:155], v[40:43]
    ds_read_b64 v[124:125], v192 offset:3648
    v_mfma_f32_16x16x32_bf16 v[44:47], v[68:71], v[152:155], v[44:47]
    ds_read_b64 v[126:127], v192 offset:3656
    v_mfma_f32_16x16x32_bf16 v[40:43], v[88:91], v[128:131], v[40:43]
    ds_read_b128 v[188:191], v193 offset:3584
    v_mfma_f32_16x16x32_bf16 v[44:47], v[88:91], v[132:135], v[44:47]
    ds_read_b128 v[48:51], v196
    v_mfma_f32_16x16x32_bf16 v[44:47], v[64:67], v[156:159], v[44:47]
    v_mfma_f32_16x16x32_bf16 v[44:47], v[92:95], v[128:131], v[44:47]
    s_cmp_ge_u32 s47, 4
    s_cbranch_scc1 L_cm
    s_setprio 0
    v_mov_b32 v52, 65520
    v_mov_b32 v53, 1
    s_mov_b64 exec, 1
    s_waitcnt vmcnt(0)
    ds_add_rtn_u32 v53, v52, v53
    s_waitcnt lgkmcnt(0)
    v_cmp_eq_u32 vcc, 3, v53
    s_nop 0
    s_cbranch_vccz L_cnl
    buffer_store_dword v15, v1, s[40:43], s20 offen sc1
L_cnl:
    s_mov_b64 exec, -1
L_cm:
    s_waitcnt lgkmcnt(0)
    s_barrier
    v_mfma_f32_16x16x32_bf16 v[20:23], v[96:99], v[164:167], v[20:23]
    v_mfma_f32_16x16x32_bf16 v[16:19], v[96:99], v[160:163], v[16:19]
    v_mfma_f32_16x16x32_bf16 v[20:23], v[100:103], v[160:163], v[20:23]
    v_mfma_f32_16x16x32_bf16 v[28:31], v[96:99], v[172:175], v[28:31]
    v_mfma_f32_16x16x32_bf16 v[24:27], v[96:99], v[168:171], v[24:27]
    v_mfma_f32_16x16x32_bf16 v[28:31], v[100:103], v[168:171], v[28:31]
    v_mfma_f32_16x16x32_bf16 v[24:27], v[100:103], v[164:167], v[24:27]
    v_mfma_f32_16x16x32_bf16 v[28:31], v[104:107], v[164:167], v[28:31]
    v_mfma_f32_16x16x32_bf16 v[24:27], v[104:107], v[160:163], v[24:27]
    v_mfma_f32_16x16x32_bf16 v[28:31], v[108:111], v[160:163], v[28:31]
    v_mfma_f32_16x16x32_bf16 v[36:39], v[96:99], v[180:183], v[36:39]
    ds_write_b128 v194, v[16:19] offset:0
    v_mfma_f32_16x16x32_bf16 v[32:35], v[96:99], v[176:179], v[32:35]
    ds_write_b128 v194, v[20:23] offset:1024
    v_mfma_f32_16x16x32_bf16 v[36:39], v[100:103], v[176:179], v[36:39]
    v_mfma_f32_16x16x32_bf16 v[32:35], v[100:103], v[172:175], v[32:35]
    v_mfma_f32_16x16x32_bf16 v[36:39], v[104:107], v[172:175], v[36:39]
    v_mfma_f32_16x16x32_bf16 v[32:35], v[104:107], v[168:171], v[32:35]
    v_mfma_f32_16x16x32_bf16 v[36:39], v[108:111], v[168:171], v[36:39]
    v_mfma_f32_16x16x32_bf16 v[32:35], v[108:111], v[164:167], v[32:35]
    ds_write_b128 v194, v[24:27] offset:2048
    v_mfma_f32_16x16x32_bf16 v[36:39], v[112:115], v[164:167], v[36:39]
    ds_write_b128 v194, v[28:31] offset:3072
    v_mfma_f32_16x16x32_bf16 v[32:35], v[112:115], v[160:163], v[32:35]
    v_mfma_f32_16x16x32_bf16 v[36:39], v[116:119], v[160:163], v[36:39]
    v_mfma_f32_16x16x32_bf16 v[44:47], v[96:99], v[188:191], v[44:47]
    v_mfma_f32_16x16x32_bf16 v[40:43], v[96:99], v[184:187], v[40:43]
    v_mfma_f32_16x16x32_bf16 v[44:47], v[100:103], v[184:187], v[44:47]
    v_mfma_f32_16x16x32_bf16 v[40:43], v[100:103], v[180:183], v[40:43]
    v_mfma_f32_16x16x32_bf16 v[44:47], v[104:107], v[180:183], v[44:47]
    v_mfma_f32_16x16x32_bf16 v[40:43], v[104:107], v[176:179], v[40:43]
    v_mfma_f32_16x16x32_bf16 v[44:47], v[108:111], v[176:179], v[44:47]
    v_mfma_f32_16x16x32_bf16 v[40:43], v[108:111], v[172:175], v[40:43]
    ds_write_b128 v194, v[32:35] offset:4096
    v_mfma_f32_16x16x32_bf16 v[44:47], v[112:115], v[172:175], v[44:47]
    ds_write_b128 v194, v[36:39] offset:5120
    v_mfma_f32_16x16x32_bf16 v[40:43], v[112:115], v[168:171], v[40:43]
    v_mfma_f32_16x16x32_bf16 v[44:47], v[116:119], v[168:171], v[44:47]
    v_mfma_f32_16x16x32_bf16 v[40:43], v[116:119], v[164:167], v[40:43]
    v_mfma_f32_16x16x32_bf16 v[44:47], v[120:123], v[164:167], v[44:47]
    v_mfma_f32_16x16x32_bf16 v[40:43], v[120:123], v[160:163], v[40:43]
    v_mfma_f32_16x16x32_bf16 v[44:47], v[124:127], v[160:163], v[44:47]
    v_and_b32 v56, 0xffff0000, v51
    v_lshlrev_b32 v57, 16, v51
    v_and_b32 v58, 0xffff0000, v50
    v_lshlrev_b32 v59, 16, v50
    v_and_b32 v60, 0xffff0000, v49
    v_lshlrev_b32 v61, 16, v49
    v_and_b32 v62, 0xffff0000, v48
    v_lshlrev_b32 v63, 16, v48
    v_and_b32 v126, 7, v0
    v_lshlrev_b32 v130, 3, v0
    v_mov_b64 v[128:129], 0
    ds_write_b128 v194, v[40:43] offset:6144
    ds_write_b128 v194, v[44:47] offset:7168
    s_cmp_lg_u32 s47, 4
    s_cbranch_scc1 L_cred
    s_mov_b32 s71, 65536
L_poll1:
    buffer_load_dword v52, v208, s[40:43], 0 offen sc1
    s_waitcnt vmcnt(0)
    v_cmp_ne_u32 vcc, s46, v52
    s_nop 0
    s_cbranch_vccz L_pollok1
    s_sub_u32 s71, s71, 1
    s_cbranch_scc0 L_poll1
L_pollok1:
L_cred:
    s_waitcnt lgkmcnt(0)
    s_barrier
    s_setprio 0
    s_lshl_b32 s62, s47, 10
    s_add_u32 m0, s62, 131072
    s_add_u32 s66, s78, s45
    buffer_load_dwordx4 v1, s[40:43], s30 offen sc1 lds
    s_add_u32 m0, s45, 32768
    s_add_u32 s67, s66, 4096
    buffer_load_dwordx4 v1, s[40:43], s66 offen sc1 lds
    buffer_load_dwordx4 v1, s[40:43], s66 offen offset:1024 sc1 lds
    s_add_u32 m0, s45, 36864
    ds_read_b128 v[64:67], v195 offset:0
    ds_read_b128 v[68:71], v195 offset:256
    ds_read_b128 v[72:75], v195 offset:8192
    ds_read_b128 v[76:79], v195 offset:8448
    ds_read_b128 v[80:83], v195 offset:16384
    ds_read_b128 v[84:87], v195 offset:16640
    ds_read_b128 v[88:91], v195 offset:24576
    ds_read_b128 v[92:95], v195 offset:24832
    buffer_load_dwordx4 v1, s[40:43], s67 offen sc1 lds
    buffer_load_dwordx4 v1, s[40:43], s67 offen offset:1024 sc1 lds
    s_waitcnt lgkmcnt(4)
    v_fma_f32 v56, v56, v198, v64
    v_fma_f32 v57, v57, v198, v65
    v_fma_f32 v58, v58, v198, v66
    v_fma_f32 v59, v59, v198, v67
    v_fma_f32 v60, v60, v198, v68
    v_fma_f32 v61, v61, v198, v69
    v_fma_f32 v62, v62, v198, v70
    v_fma_f32 v63, v63, v198, v71
    v_pk_add_f32 v[56:57], v[56:57], v[72:73]
    v_pk_add_f32 v[58:59], v[58:59], v[74:75]
    v_pk_add_f32 v[60:61], v[60:61], v[76:77]
    v_pk_add_f32 v[62:63], v[62:63], v[78:79]
    s_waitcnt lgkmcnt(0)
    s_cmp_lg_u32 s47, 0
    s_cbranch_scc1 L_nclr
    s_mov_b64 exec, 0xffff
    ds_write_b64 v130, v[128:129]
    s_mov_b64 exec, -1
L_nclr:
    v_pk_add_f32 v[80:81], v[80:81], v[88:89]
    v_pk_add_f32 v[82:83], v[82:83], v[90:91]
    v_pk_add_f32 v[84:85], v[84:85], v[92:93]
    v_pk_add_f32 v[86:87], v[86:87], v[94:95]
    v_pk_add_f32 v[56:57], v[56:57], v[80:81]
    v_pk_add_f32 v[58:59], v[58:59], v[82:83]
    v_pk_add_f32 v[60:61], v[60:61], v[84:85]
    v_pk_add_f32 v[62:63], v[62:63], v[86:87]
    v_cvt_pk_bf16_f32 v104, v56, v57
    v_cvt_pk_bf16_f32 v105, v58, v59
    v_cvt_pk_bf16_f32 v106, v60, v61
    v_cvt_pk_bf16_f32 v107, v62, v63
    v_mov_b64 v[108:109], -1
    v_mov_b64 v[110:111], -1
    s_add_u32 m0, s28, 65536
    s_add_u32 s66, s3, 32768
    buffer_load_dwordx4 v1, s[40:43], s66 offen offset:0 sc1 lds
    buffer_load_dwordx4 v1, s[40:43], s66 offen offset:1024 sc1 lds
    buffer_load_dwordx4 v1, s[40:43], s66 offen offset:2048 sc1 lds
    v_mov_b32 v124, s47
    s_and_b32 s57, s47, 4
    v_and_or_b32 v125, v0, 3, s57
    v_xor_b32 v180, 2048, v201
    s_add_u32 s57, s28, 131072
    v_add_u32 v181, s57, v1
    v_xor_b32 v182, 4096, v181
    s_waitcnt vmcnt(5)
L_att:
    s_cmp_lg_u32 s70, 0
    s_barrier
    s_cbranch_scc1 L_haveq
    ds_read_b128 v[132:135], v180
    ds_read_b128 v[96:99], v1 offset:32768
    ds_read_b128 v[136:139], v180 offset:1024
    ds_read_b128 v[100:103], v1 offset:33792
    ds_read_b128 v[16:19], v201
    ds_read_b128 v[20:23], v201 offset:1024
L_haveq:
    ds_read_b128 v[24:27], v199 offset:0
    ds_read_b128 v[28:31], v199 offset:1024
    ds_read_b128 v[32:35], v199 offset:2048
    buffer_load_dwordx4 v1, s[40:43], s66 offen offset:3072 sc1 lds
    s_cbranch_scc1 L_havem
    s_waitcnt lgkmcnt(7)
    v_mfma_f32_32x32x16_bf16 v[64:79], v[96:99], v[132:135], 0
    s_waitcnt lgkmcnt(5)
    v_mfma_f32_32x32x16_bf16 v[64:79], v[100:103], v[136:139], v[64:79]
    s_waitcnt lgkmcnt(3)
    v_mfma_f32_32x32x16_bf16 v[80:95], v[96:99], v[16:19], 0
    v_mfma_f32_32x32x16_bf16 v[80:95], v[100:103], v[20:23], v[80:95]
L_havem:
    s_waitcnt lgkmcnt(0)
    v_mfma_f32_32x32x16_bf16 v[48:63], v[24:27], v[132:135], 0
    s_cbranch_scc1 L_hm
    s_nop 5
    v_max3_f32 v183, v65, v66, v64
    s_nop 1
    v_max3_f32 v14, v81, v82, v80
    v_max3_f32 v183, v67, v68, v183
    v_max3_f32 v14, v83, v84, v14
L_hm:
    s_nop 1
    v_permlane32_swap_b32 v183, v14
    v_max_f32 v96, v183, v14
    v_xor_b32 v96, 0x80000000, v96
    v_and_b32 v97, 0xffff0000, v96
    v_sub_f32 v96, v96, v97
    v_and_b32 v98, 0xffff0000, v96
    v_sub_f32 v96, v96, v98
    v_lshrrev_b32 v97, 16, v97
    v_lshrrev_b32 v99, 16, v96
    v_or_b32 v98, v97, v98
    s_mov_b32 exec_lo, 0
    v_mov_b64 v[22:23], v[98:99]
    s_mov_b32 exec_lo, -1
    v_permlane32_swap_b32 v138, v98
    v_permlane32_swap_b32 v139, v99
    s_nop 1
    v_mfma_f32_32x32x16_bf16 v[48:63], v[28:31], v[136:139], v[48:63]
    s_waitcnt vmcnt(4)
    s_barrier
    s_setprio 2
    v_mfma_f32_32x32x16_bf16 v[64:79], v[24:27], v[16:19], 0
    ds_read_b128 v[24:27], v199 offset:4096
    s_nop 6
    v_exp_f32 v48, v48
    v_exp_f32 v49, v49
    v_exp_f32 v50, v50
    v_exp_f32 v51, v51
    v_cvt_pk_bf16_f32 v40, v48, v49
    v_cvt_pk_bf16_f32 v41, v50, v51
    v_mfma_f32_32x32x16_bf16 v[64:79], v[28:31], v[20:23], v[64:79]
    ds_read_b128 v[28:31], v199 offset:5120
    v_exp_f32 v52, v52
    v_exp_f32 v53, v53
    v_exp_f32 v54, v54
    v_exp_f32 v55, v55
    v_cvt_pk_bf16_f32 v42, v52, v53
    v_cvt_pk_bf16_f32 v43, v54, v55
    ds_read_b128 v[36:39], v199 offset:3072
    s_waitcnt vmcnt(0)
    ds_write_b8 v124, v108 offset:0
    v_exp_f32 v56, v56
    s_add_u32 m0, s28, 98304
    v_exp_f32 v57, v57
    s_add_u32 s66, s3, 65536
    v_exp_f32 v58, v58
    buffer_load_dwordx4 v1, s[40:43], s66 offen offset:0 sc1 lds
    v_exp_f32 v59, v59
    v_cvt_pk_bf16_f32 v44, v56, v57
    v_cvt_pk_bf16_f32 v45, v58, v59
    v_mfma_f32_32x32x16_bf16 v[148:163], v[32:35], v[40:43], 0
    v_exp_f32 v60, v60
    buffer_load_dwordx4 v1, s[40:43], s66 offen offset:1024 sc1 lds
    v_exp_f32 v61, v61
    v_exp_f32 v62, v62
    v_exp_f32 v63, v63
    v_cvt_pk_bf16_f32 v46, v60, v61
    v_cvt_pk_bf16_f32 v47, v62, v63
    s_setprio 1
    s_waitcnt lgkmcnt(3)
    v_mfma_f32_32x32x16_bf16 v[48:63], v[24:27], v[132:135], 0
    v_exp_f32 v64, v64
    buffer_load_dwordx4 v1, s[40:43], s66 offen offset:2048 sc1 lds
    v_exp_f32 v65, v65
    v_exp_f32 v66, v66
    v_exp_f32 v67, v67
    v_cvt_pk_bf16_f32 v40, v64, v65
    v_cvt_pk_bf16_f32 v41, v66, v67
    s_waitcnt lgkmcnt(2)
    v_mfma_f32_32x32x16_bf16 v[48:63], v[28:31], v[136:139], v[48:63]
    v_exp_f32 v68, v68
    buffer_load_dwordx4 v1, s[40:43], s66 offen offset:3072 sc1 lds
    v_exp_f32 v69, v69
    v_exp_f32 v70, v70
    v_exp_f32 v71, v71
    v_cvt_pk_bf16_f32 v42, v68, v69
    v_cvt_pk_bf16_f32 v43, v70, v71
    s_waitcnt lgkmcnt(1)
    v_mfma_f32_32x32x16_bf16 v[148:163], v[36:39], v[44:47], v[148:163]
    ds_read_u8 v127, v125 offset:0
    v_exp_f32 v72, v72
    v_exp_f32 v73, v73
    v_exp_f32 v74, v74
    v_exp_f32 v75, v75
    v_cvt_pk_bf16_f32 v44, v72, v73
    v_cvt_pk_bf16_f32 v45, v74, v75
    s_setprio 0
    v_mfma_f32_32x32x16_bf16 v[80:95], v[32:35], v[40:43], 0
    ds_read_b128 v[32:35], v199 offset:6144
    v_exp_f32 v76, v76
    v_exp_f32 v77, v77
    v_exp_f32 v78, v78
    v_exp_f32 v79, v79
    s_waitcnt lgkmcnt(1)
    v_cmp_eq_u32 vcc, 0, v127
    v_cvt_pk_bf16_f32 v46, v76, v77
    v_cvt_pk_bf16_f32 v47, v78, v79
    s_cbranch_vccnz L_sp1
L_spr1:
    s_setprio 3
    v_mfma_f32_32x32x16_bf16 v[64:79], v[24:27], v[16:19], 0
    ds_read_b128 v[24:27], v199 offset:32768
    v_exp_f32 v48, v48
    buffer_store_dwordx4 v[104:107], v197, s[40:43], s26 offen sc1
    v_exp_f32 v49, v49
    v_exp_f32 v50, v50
    v_exp_f32 v51, v51
    v_cvt_pk_bf16_f32 v40, v48, v49
    v_cvt_pk_bf16_f32 v41, v50, v51
    v_mfma_f32_32x32x16_bf16 v[64:79], v[28:31], v[20:23], v[64:79]
    ds_read_b128 v[28:31], v199 offset:33792
    v_exp_f32 v52, v52
    buffer_store_dwordx4 v[108:111], v1, s[40:43], s44 offen sc1
    v_exp_f32 v53, v53
    v_exp_f32 v54, v54
    v_exp_f32 v55, v55
    v_cvt_pk_bf16_f32 v42, v52, v53
    v_cvt_pk_bf16_f32 v43, v54, v55
    v_mfma_f32_32x32x16_bf16 v[80:95], v[36:39], v[44:47], v[80:95]
    ds_read_b128 v[36:39], v199 offset:7168
    v_exp_f32 v56, v56
    v_exp_f32 v57, v57
    v_exp_f32 v58, v58
    v_exp_f32 v59, v59
    v_cvt_pk_bf16_f32 v44, v56, v57
    v_cvt_pk_bf16_f32 v45, v58, v59
    s_waitcnt lgkmcnt(3)
    v_mfma_f32_32x32x16_bf16 v[148:163], v[32:35], v[40:43], v[148:163]
    v_exp_f32 v60, v60
    v_exp_f32 v61, v61
    v_exp_f32 v62, v62
    v_exp_f32 v63, v63
    v_cvt_pk_bf16_f32 v46, v60, v61
    v_cvt_pk_bf16_f32 v47, v62, v63
    s_waitcnt lgkmcnt(2)
    v_mfma_f32_32x32x16_bf16 v[48:63], v[24:27], v[132:135], 0
    v_exp_f32 v64, v64
    v_exp_f32 v65, v65
    v_exp_f32 v66, v66
    v_exp_f32 v67, v67
    v_cvt_pk_bf16_f32 v40, v64, v65
    v_cvt_pk_bf16_f32 v41, v66, v67
    s_waitcnt lgkmcnt(1)
    v_mfma_f32_32x32x16_bf16 v[48:63], v[28:31], v[136:139], v[48:63]
    v_exp_f32 v68, v68
    v_exp_f32 v69, v69
    v_exp_f32 v70, v70
    v_exp_f32 v71, v71
    v_cvt_pk_bf16_f32 v42, v68, v69
    v_cvt_pk_bf16_f32 v43, v70, v71
    s_waitcnt lgkmcnt(0)
    v_mfma_f32_32x32x16_bf16 v[148:163], v[36:39], v[44:47], v[148:163]
    v_exp_f32 v72, v72
    v_exp_f32 v73, v73
    v_exp_f32 v74, v74
    v_exp_f32 v75, v75
    v_cvt_pk_bf16_f32 v44, v72, v73
    v_cvt_pk_bf16_f32 v45, v74, v75
    s_setprio 2
    v_mfma_f32_32x32x16_bf16 v[80:95], v[32:35], v[40:43], v[80:95]
    ds_read_b128 v[32:35], v199 offset:34816
    v_exp_f32 v76, v76
    v_exp_f32 v77, v77
    v_exp_f32 v78, v78
    v_exp_f32 v79, v79
    v_cvt_pk_bf16_f32 v46, v76, v77
    v_cvt_pk_bf16_f32 v47, v78, v79
    v_mfma_f32_32x32x16_bf16 v[64:79], v[24:27], v[16:19], 0
    ds_read_b128 v[24:27], v199 offset:36864
    s_waitcnt vmcnt(2)
    ds_write_b8 v124, v108 offset:8
    v_exp_f32 v48, v48
    s_add_u32 m0, s28, 131072
    v_exp_f32 v49, v49
    s_add_u32 s66, s3, 98304
    v_exp_f32 v50, v50
    buffer_load_dwordx4 v1, s[40:43], s66 offen offset:0 sc1 lds
    v_exp_f32 v51, v51
    v_cvt_pk_bf16_f32 v40, v48, v49
    v_cvt_pk_bf16_f32 v41, v50, v51
    v_mfma_f32_32x32x16_bf16 v[64:79], v[28:31], v[20:23], v[64:79]
    ds_read_b128 v[28:31], v199 offset:37888
    v_exp_f32 v52, v52
    buffer_load_dwordx4 v1, s[40:43], s66 offen offset:1024 sc1 lds
    v_exp_f32 v53, v53
    v_exp_f32 v54, v54
    v_exp_f32 v55, v55
    v_cvt_pk_bf16_f32 v42, v52, v53
    v_cvt_pk_bf16_f32 v43, v54, v55
    v_mfma_f32_32x32x16_bf16 v[80:95], v[36:39], v[44:47], v[80:95]
    ds_read_b128 v[36:39], v199 offset:35840
    v_exp_f32 v56, v56
    buffer_load_dwordx4 v1, s[40:43], s66 offen offset:2048 sc1 lds
    v_exp_f32 v57, v57
    v_exp_f32 v58, v58
    v_exp_f32 v59, v59
    v_cvt_pk_bf16_f32 v44, v56, v57
    v_cvt_pk_bf16_f32 v45, v58, v59
    s_waitcnt lgkmcnt(4)
    v_mfma_f32_32x32x16_bf16 v[148:163], v[32:35], v[40:43], v[148:163]
    v_exp_f32 v60, v60
    buffer_load_dwordx4 v1, s[40:43], s66 offen offset:3072 sc1 lds
    v_exp_f32 v61, v61
    v_exp_f32 v62, v62
    v_exp_f32 v63, v63
    v_cvt_pk_bf16_f32 v46, v60, v61
    v_cvt_pk_bf16_f32 v47, v62, v63
    s_setprio 1
    s_waitcnt lgkmcnt(3)
    v_mfma_f32_32x32x16_bf16 v[48:63], v[24:27], v[132:135], 0
    v_exp_f32 v64, v64
    v_exp_f32 v65, v65
    v_exp_f32 v66, v66
    v_exp_f32 v67, v67
    v_cvt_pk_bf16_f32 v40, v64, v65
    v_cvt_pk_bf16_f32 v41, v66, v67
    s_waitcnt lgkmcnt(1)
    v_mfma_f32_32x32x16_bf16 v[48:63], v[28:31], v[136:139], v[48:63]
    ds_read_u8 v127, v125 offset:8
    v_exp_f32 v68, v68
    v_exp_f32 v69, v69
    v_exp_f32 v70, v70
    v_exp_f32 v71, v71
    v_cvt_pk_bf16_f32 v42, v68, v69
    v_cvt_pk_bf16_f32 v43, v70, v71
    s_waitcnt lgkmcnt(1)
    v_mfma_f32_32x32x16_bf16 v[148:163], v[36:39], v[44:47], v[148:163]
    v_exp_f32 v72, v72
    v_exp_f32 v73, v73
    v_exp_f32 v74, v74
    v_exp_f32 v75, v75
    v_cvt_pk_bf16_f32 v44, v72, v73
    v_cvt_pk_bf16_f32 v45, v74, v75
    s_setprio 0
    v_mfma_f32_32x32x16_bf16 v[80:95], v[32:35], v[40:43], v[80:95]
    ds_read_b128 v[32:35], v199 offset:38912
    v_exp_f32 v76, v76
    v_exp_f32 v77, v77
    v_exp_f32 v78, v78
    v_exp_f32 v79, v79
    s_waitcnt lgkmcnt(1)
    v_cmp_eq_u32 vcc, 0, v127
    v_cvt_pk_bf16_f32 v46, v76, v77
    v_cvt_pk_bf16_f32 v47, v78, v79
    s_cbranch_vccnz L_sp2
L_spr2:
    s_setprio 3
    v_mfma_f32_32x32x16_bf16 v[64:79], v[24:27], v[16:19], 0
    ds_read_b128 v[24:27], v200 offset:0
    v_exp_f32 v48, v48
    v_exp_f32 v49, v49
    v_exp_f32 v50, v50
    v_exp_f32 v51, v51
    v_cvt_pk_bf16_f32 v40, v48, v49
    v_cvt_pk_bf16_f32 v41, v50, v51
    v_mfma_f32_32x32x16_bf16 v[64:79], v[28:31], v[20:23], v[64:79]
    ds_read_b128 v[28:31], v200 offset:1024
    v_exp_f32 v52, v52
    v_exp_f32 v53, v53
    v_exp_f32 v54, v54
    v_exp_f32 v55, v55
    v_cvt_pk_bf16_f32 v42, v52, v53
    v_cvt_pk_bf16_f32 v43, v54, v55
    v_mfma_f32_32x32x16_bf16 v[80:95], v[36:39], v[44:47], v[80:95]
    ds_read_b128 v[36:39], v199 offset:39936
    v_exp_f32 v56, v56
    v_exp_f32 v57, v57
    v_exp_f32 v58, v58
    v_exp_f32 v59, v59
    v_cvt_pk_bf16_f32 v44, v56, v57
    v_cvt_pk_bf16_f32 v45, v58, v59
    s_waitcnt lgkmcnt(3)
    v_mfma_f32_32x32x16_bf16 v[148:163], v[32:35], v[40:43], v[148:163]
    v_exp_f32 v60, v60
    v_exp_f32 v61, v61
    v_exp_f32 v62, v62
    v_exp_f32 v63, v63
    v_cvt_pk_bf16_f32 v46, v60, v61
    v_cvt_pk_bf16_f32 v47, v62, v63
    s_waitcnt lgkmcnt(2)
    v_mfma_f32_32x32x16_bf16 v[48:63], v[24:27], v[132:135], 0
    v_exp_f32 v64, v64
    v_exp_f32 v65, v65
    v_exp_f32 v66, v66
    v_exp_f32 v67, v67
    v_cvt_pk_bf16_f32 v40, v64, v65
    v_cvt_pk_bf16_f32 v41, v66, v67
    s_waitcnt lgkmcnt(1)
    v_mfma_f32_32x32x16_bf16 v[48:63], v[28:31], v[136:139], v[48:63]
    v_exp_f32 v68, v68
    v_exp_f32 v69, v69
    v_exp_f32 v70, v70
    v_exp_f32 v71, v71
    v_cvt_pk_bf16_f32 v42, v68, v69
    v_cvt_pk_bf16_f32 v43, v70, v71
    s_waitcnt lgkmcnt(0)
    v_mfma_f32_32x32x16_bf16 v[148:163], v[36:39], v[44:47], v[148:163]
    v_exp_f32 v72, v72
    v_exp_f32 v73, v73
    v_exp_f32 v74, v74
    v_exp_f32 v75, v75
    v_cvt_pk_bf16_f32 v44, v72, v73
    v_cvt_pk_bf16_f32 v45, v74, v75
    s_setprio 2
    v_mfma_f32_32x32x16_bf16 v[80:95], v[32:35], v[40:43], v[80:95]
    ds_read_b128 v[32:35], v200 offset:2048
    v_exp_f32 v76, v76
    v_exp_f32 v77, v77
    v_exp_f32 v78, v78
    v_exp_f32 v79, v79
    v_cvt_pk_bf16_f32 v46, v76, v77
    v_cvt_pk_bf16_f32 v47, v78, v79
    v_mfma_f32_32x32x16_bf16 v[64:79], v[24:27], v[16:19], 0
    ds_read_b128 v[24:27], v200 offset:4096
    s_waitcnt vmcnt(0)
    ds_write_b8 v124, v108 offset:16
    v_exp_f32 v48, v48
    s_add_u32 m0, s28, 32768
    v_exp_f32 v49, v49
    s_add_u32 s66, s3, 131072
    v_exp_f32 v50, v50
    buffer_load_dwordx4 v1, s[40:43], s66 offen offset:0 sc1 lds
    v_exp_f32 v51, v51
    v_cvt_pk_bf16_f32 v40, v48, v49
    v_cvt_pk_bf16_f32 v41, v50, v51
    v_mfma_f32_32x32x16_bf16 v[64:79], v[28:31], v[20:23], v[64:79]
    ds_read_b128 v[28:31], v200 offset:5120
    v_exp_f32 v52, v52
    buffer_load_dwordx4 v1, s[40:43], s66 offen offset:1024 sc1 lds
    v_exp_f32 v53, v53
    v_exp_f32 v54, v54
    v_exp_f32 v55, v55
    v_cvt_pk_bf16_f32 v42, v52, v53
    v_cvt_pk_bf16_f32 v43, v54, v55
    v_mfma_f32_32x32x16_bf16 v[80:95], v[36:39], v[44:47], v[80:95]
    ds_read_b128 v[36:39], v200 offset:3072
    v_exp_f32 v56, v56
    buffer_load_dwordx4 v1, s[40:43], s66 offen offset:2048 sc1 lds
    v_exp_f32 v57, v57
    v_exp_f32 v58, v58
    v_exp_f32 v59, v59
    v_cvt_pk_bf16_f32 v44, v56, v57
    v_cvt_pk_bf16_f32 v45, v58, v59
    s_waitcnt lgkmcnt(4)
    v_mfma_f32_32x32x16_bf16 v[148:163], v[32:35], v[40:43], v[148:163]
    v_exp_f32 v60, v60
    buffer_load_dwordx4 v1, s[40:43], s66 offen offset:3072 sc1 lds
    v_exp_f32 v61, v61
    v_exp_f32 v62, v62
    v_exp_f32 v63, v63
    v_cvt_pk_bf16_f32 v46, v60, v61
    v_cvt_pk_bf16_f32 v47, v62, v63
    s_setprio 1
    s_waitcnt lgkmcnt(3)
    v_mfma_f32_32x32x16_bf16 v[48:63], v[24:27], v[132:135], 0
    v_exp_f32 v64, v64
    s_add_u32 m0, s79, 128
    v_exp_f32 v65, v65
    s_mov_b32 s67, 0
    v_exp_f32 v66, v66
    buffer_load_dwordx4 v202, s[12:15], s67 offen lds
    v_exp_f32 v67, v67
    v_cvt_pk_bf16_f32 v40, v64, v65
    v_cvt_pk_bf16_f32 v41, v66, v67
    s_waitcnt lgkmcnt(1)
    v_mfma_f32_32x32x16_bf16 v[48:63], v[28:31], v[136:139], v[48:63]
    ds_read_u8 v127, v126 offset:16
    v_exp_f32 v68, v68
    v_exp_f32 v69, v69
    v_exp_f32 v70, v70
    v_exp_f32 v71, v71
    v_cvt_pk_bf16_f32 v42, v68, v69
    v_cvt_pk_bf16_f32 v43, v70, v71
    s_waitcnt lgkmcnt(1)
    v_mfma_f32_32x32x16_bf16 v[148:163], v[36:39], v[44:47], v[148:163]
    v_exp_f32 v72, v72
    v_exp_f32 v73, v73
    v_exp_f32 v74, v74
    v_exp_f32 v75, v75
    v_cvt_pk_bf16_f32 v44, v72, v73
    v_cvt_pk_bf16_f32 v45, v74, v75
    s_setprio 0
    v_mfma_f32_32x32x16_bf16 v[80:95], v[32:35], v[40:43], v[80:95]
    ds_read_b128 v[32:35], v200 offset:6144
    v_exp_f32 v76, v76
    v_exp_f32 v77, v77
    v_exp_f32 v78, v78
    v_exp_f32 v79, v79
    s_waitcnt lgkmcnt(1)
    v_cmp_eq_u32 vcc, 0, v127
    v_cvt_pk_bf16_f32 v46, v76, v77
    v_cvt_pk_bf16_f32 v47, v78, v79
    s_cbranch_vccnz L_sp3
L_spr3:
    s_setprio 3
    v_mfma_f32_32x32x16_bf16 v[64:79], v[24:27], v[16:19], 0
    ds_read_b128 v[24:27], v200 offset:32768
    v_exp_f32 v48, v48
    v_exp_f32 v49, v49
    v_exp_f32 v50, v50
    v_exp_f32 v51, v51
    v_cvt_pk_bf16_f32 v40, v48, v49
    v_cvt_pk_bf16_f32 v41, v50, v51
    v_mfma_f32_32x32x16_bf16 v[64:79], v[28:31], v[20:23], v[64:79]
    ds_read_b128 v[28:31], v200 offset:33792
    v_exp_f32 v52, v52
    v_exp_f32 v53, v53
    v_exp_f32 v54, v54
    v_exp_f32 v55, v55
    v_cvt_pk_bf16_f32 v42, v52, v53
    v_cvt_pk_bf16_f32 v43, v54, v55
    v_mfma_f32_32x32x16_bf16 v[80:95], v[36:39], v[44:47], v[80:95]
    ds_read_b128 v[36:39], v200 offset:7168
    v_exp_f32 v56, v56
    v_exp_f32 v57, v57
    v_exp_f32 v58, v58
    v_exp_f32 v59, v59
    v_cvt_pk_bf16_f32 v44, v56, v57
    v_cvt_pk_bf16_f32 v45, v58, v59
    s_waitcnt lgkmcnt(3)
    v_mfma_f32_32x32x16_bf16 v[148:163], v[32:35], v[40:43], v[148:163]
    v_exp_f32 v60, v60
    v_exp_f32 v61, v61
    v_exp_f32 v62, v62
    v_exp_f32 v63, v63
    v_cvt_pk_bf16_f32 v46, v60, v61
    v_cvt_pk_bf16_f32 v47, v62, v63
    s_waitcnt lgkmcnt(2)
    v_mfma_f32_32x32x16_bf16 v[48:63], v[24:27], v[132:135], 0
    v_exp_f32 v64, v64
    v_exp_f32 v65, v65
    v_exp_f32 v66, v66
    v_exp_f32 v67, v67
    v_cvt_pk_bf16_f32 v40, v64, v65
    v_cvt_pk_bf16_f32 v41, v66, v67
    s_waitcnt lgkmcnt(1)
    v_mfma_f32_32x32x16_bf16 v[48:63], v[28:31], v[136:139], v[48:63]
    v_exp_f32 v68, v68
    v_exp_f32 v69, v69
    v_exp_f32 v70, v70
    v_exp_f32 v71, v71
    v_cvt_pk_bf16_f32 v42, v68, v69
    v_cvt_pk_bf16_f32 v43, v70, v71
    s_waitcnt lgkmcnt(0)
    v_mfma_f32_32x32x16_bf16 v[148:163], v[36:39], v[44:47], v[148:163]
    v_exp_f32 v72, v72
    v_exp_f32 v73, v73
    v_exp_f32 v74, v74
    v_exp_f32 v75, v75
    v_cvt_pk_bf16_f32 v44, v72, v73
    v_cvt_pk_bf16_f32 v45, v74, v75
    s_setprio 2
    v_mfma_f32_32x32x16_bf16 v[80:95], v[32:35], v[40:43], v[80:95]
    ds_read_b128 v[32:35], v200 offset:34816
    v_exp_f32 v76, v76
    v_exp_f32 v77, v77
    v_exp_f32 v78, v78
    v_exp_f32 v79, v79
    v_cvt_pk_bf16_f32 v46, v76, v77
    v_cvt_pk_bf16_f32 v47, v78, v79
    v_mfma_f32_32x32x16_bf16 v[64:79], v[24:27], v[16:19], 0
    ds_read_b128 v[24:27], v200 offset:36864
    s_waitcnt vmcnt(0)
    ds_write_b8 v124, v108 offset:24
    v_exp_f32 v48, v48
    s_add_u32 m0, s28, 65536
    v_exp_f32 v49, v49
    s_add_u32 s66, s3, 163840
    v_exp_f32 v50, v50
    buffer_load_dwordx4 v1, s[40:43], s66 offen offset:0 sc1 lds
    v_exp_f32 v51, v51
    v_cvt_pk_bf16_f32 v40, v48, v49
    v_cvt_pk_bf16_f32 v41, v50, v51
    v_mfma_f32_32x32x16_bf16 v[64:79], v[28:31], v[20:23], v[64:79]
    ds_read_b128 v[28:31], v200 offset:37888
    v_exp_f32 v52, v52
    buffer_load_dwordx4 v1, s[40:43], s66 offen offset:1024 sc1 lds
    v_exp_f32 v53, v53
    v_exp_f32 v54, v54
    v_exp_f32 v55, v55
    v_cvt_pk_bf16_f32 v42, v52, v53
    v_cvt_pk_bf16_f32 v43, v54, v55
    v_mfma_f32_32x32x16_bf16 v[80:95], v[36:39], v[44:47], v[80:95]
    ds_read_b128 v[36:39], v200 offset:35840
    v_exp_f32 v56, v56
    buffer_load_dwordx4 v1, s[40:43], s66 offen offset:2048 sc1 lds
    v_exp_f32 v57, v57
    v_exp_f32 v58, v58
    v_exp_f32 v59, v59
    v_cvt_pk_bf16_f32 v44, v56, v57
    v_cvt_pk_bf16_f32 v45, v58, v59
    s_waitcnt lgkmcnt(4)
    v_mfma_f32_32x32x16_bf16 v[148:163], v[32:35], v[40:43], v[148:163]
    v_exp_f32 v60, v60
    buffer_load_dwordx4 v1, s[40:43], s66 offen offset:3072 sc1 lds
    v_exp_f32 v61, v61
    v_exp_f32 v62, v62
    v_exp_f32 v63, v63
    v_cvt_pk_bf16_f32 v46, v60, v61
    v_cvt_pk_bf16_f32 v47, v62, v63
    s_setprio 1
    s_waitcnt lgkmcnt(3)
    v_mfma_f32_32x32x16_bf16 v[48:63], v[24:27], v[132:135], 0
    v_exp_f32 v64, v64
    s_add_u32 m0, s79, 7296
    v_exp_f32 v65, v65
    s_mov_b32 s67, 28672
    v_exp_f32 v66, v66
    buffer_load_dwordx4 v202, s[12:15], s67 offen lds
    v_exp_f32 v67, v67
    v_cvt_pk_bf16_f32 v40, v64, v65
    v_cvt_pk_bf16_f32 v41, v66, v67
    s_waitcnt lgkmcnt(1)
    v_mfma_f32_32x32x16_bf16 v[48:63], v[28:31], v[136:139], v[48:63]
    ds_read_u8 v127, v125 offset:24
    v_exp_f32 v68, v68
    v_exp_f32 v69, v69
    v_exp_f32 v70, v70
    v_exp_f32 v71, v71
    v_cvt_pk_bf16_f32 v42, v68, v69
    v_cvt_pk_bf16_f32 v43, v70, v71
    s_waitcnt lgkmcnt(1)
    v_mfma_f32_32x32x16_bf16 v[148:163], v[36:39], v[44:47], v[148:163]
    v_exp_f32 v72, v72
    v_exp_f32 v73, v73
    v_exp_f32 v74, v74
    v_exp_f32 v75, v75
    v_cvt_pk_bf16_f32 v44, v72, v73
    v_cvt_pk_bf16_f32 v45, v74, v75
    s_movk_i32 s62, 3584
    s_cmp_ge_u32 s47, 4
    s_cbranch_scc1 L_ldq
    s_cmp_lg_u32 s47, 3
    s_cbranch_scc1 L_ldq_r
    s_lshl_b32 s57, s2, 2
    s_add_u32 s57, s57, 12288
    s_mov_b64 exec, 1
    buffer_store_dword v15, v1, s[40:43], s57 offen sc1
    s_mov_b64 exec, -1
    s_branch L_ldq_r
L_ldq:
    buffer_load_dword v240, v211, s[16:19], 0 offen offset:0
    buffer_load_dword v241, v211, s[16:19], 0 offen offset:896
    buffer_load_dword v242, v211, s[16:19], 0 offen offset:1792
    buffer_load_dword v243, v211, s[16:19], 0 offen offset:2688
    buffer_load_dword v244, v211, s[16:19], s62 offen offset:0
    buffer_load_dword v245, v211, s[16:19], s62 offen offset:896
    buffer_load_dword v246, v211, s[16:19], s62 offen offset:1792
    buffer_load_dword v247, v211, s[16:19], s62 offen offset:2688
L_ldq_r:
    s_setprio 0
    v_mfma_f32_32x32x16_bf16 v[80:95], v[32:35], v[40:43], v[80:95]
    ds_read_b128 v[32:35], v200 offset:38912
    v_exp_f32 v76, v76
    v_exp_f32 v77, v77
    v_exp_f32 v78, v78
    v_exp_f32 v79, v79
    s_waitcnt lgkmcnt(1)
    v_cmp_eq_u32 vcc, 0, v127
    v_cvt_pk_bf16_f32 v46, v76, v77
    v_cvt_pk_bf16_f32 v47, v78, v79
    s_cbranch_vccnz L_sp4
L_spr4:
    s_setprio 3
    v_mfma_f32_32x32x16_bf16 v[64:79], v[24:27], v[16:19], 0
    ds_read_b128 v[24:27], v199 offset:0
    v_exp_f32 v48, v48
    v_exp_f32 v49, v49
    v_exp_f32 v50, v50
    v_exp_f32 v51, v51
    v_cvt_pk_bf16_f32 v40, v48, v49
    v_cvt_pk_bf16_f32 v41, v50, v51
    v_mfma_f32_32x32x16_bf16 v[64:79], v[28:31], v[20:23], v[64:79]
    ds_read_b128 v[28:31], v199 offset:1024
    v_exp_f32 v52, v52
    v_exp_f32 v53, v53
    v_exp_f32 v54, v54
    v_exp_f32 v55, v55
    v_cvt_pk_bf16_f32 v42, v52, v53
    v_cvt_pk_bf16_f32 v43, v54, v55
    v_mfma_f32_32x32x16_bf16 v[80:95], v[36:39], v[44:47], v[80:95]
    ds_read_b128 v[36:39], v200 offset:39936
    v_exp_f32 v56, v56
    v_exp_f32 v57, v57
    v_exp_f32 v58, v58
    v_exp_f32 v59, v59
    v_cvt_pk_bf16_f32 v44, v56, v57
    v_cvt_pk_bf16_f32 v45, v58, v59
    s_waitcnt lgkmcnt(3)
    v_mfma_f32_32x32x16_bf16 v[148:163], v[32:35], v[40:43], v[148:163]
    v_exp_f32 v60, v60
    v_exp_f32 v61, v61
    v_exp_f32 v62, v62
    v_exp_f32 v63, v63
    v_cvt_pk_bf16_f32 v46, v60, v61
    v_cvt_pk_bf16_f32 v47, v62, v63
    s_waitcnt lgkmcnt(2)
    v_mfma_f32_32x32x16_bf16 v[48:63], v[24:27], v[132:135], 0
    v_exp_f32 v64, v64
    v_exp_f32 v65, v65
    v_exp_f32 v66, v66
    v_exp_f32 v67, v67
    v_cvt_pk_bf16_f32 v40, v64, v65
    v_cvt_pk_bf16_f32 v41, v66, v67
    s_waitcnt lgkmcnt(1)
    v_mfma_f32_32x32x16_bf16 v[48:63], v[28:31], v[136:139], v[48:63]
    v_exp_f32 v68, v68
    v_exp_f32 v69, v69
    v_exp_f32 v70, v70
    v_exp_f32 v71, v71
    v_cvt_pk_bf16_f32 v42, v68, v69
    v_cvt_pk_bf16_f32 v43, v70, v71
    s_waitcnt lgkmcnt(0)
    v_mfma_f32_32x32x16_bf16 v[148:163], v[36:39], v[44:47], v[148:163]
    v_exp_f32 v72, v72
    v_exp_f32 v73, v73
    v_exp_f32 v74, v74
    v_exp_f32 v75, v75
    v_cvt_pk_bf16_f32 v44, v72, v73
    v_cvt_pk_bf16_f32 v45, v74, v75
    s_setprio 2
    v_mfma_f32_32x32x16_bf16 v[80:95], v[32:35], v[40:43], v[80:95]
    ds_read_b128 v[32:35], v199 offset:2048
    v_exp_f32 v76, v76
    v_exp_f32 v77, v77
    v_exp_f32 v78, v78
    v_exp_f32 v79, v79
    v_cvt_pk_bf16_f32 v46, v76, v77
    v_cvt_pk_bf16_f32 v47, v78, v79
    v_mfma_f32_32x32x16_bf16 v[64:79], v[24:27], v[16:19], 0
    ds_read_b128 v[24:27], v199 offset:4096
    s_cmp_ge_u32 s47, 4
    s_cbranch_scc1 L_w4
    s_cmp_eq_u32 s47, 3
    s_waitcnt vmcnt(1)
    s_cbranch_scc1 L_w4
    s_waitcnt vmcnt(0)
L_w4:
    s_waitcnt vmcnt(8)
    ds_write_b8 v124, v108 offset:32
    v_exp_f32 v48, v48
    s_add_u32 m0, s28, 98304
    v_exp_f32 v49, v49
    s_add_u32 s66, s3, 196608
    v_exp_f32 v50, v50
    buffer_load_dwordx4 v1, s[40:43], s66 offen offset:0 sc1 lds
    v_exp_f32 v51, v51
    v_cvt_pk_bf16_f32 v40, v48, v49
    v_cvt_pk_bf16_f32 v41, v50, v51
    v_mfma_f32_32x32x16_bf16 v[64:79], v[28:31], v[20:23], v[64:79]
    ds_read_b128 v[28:31], v199 offset:5120
    v_exp_f32 v52, v52
    buffer_load_dwordx4 v1, s[40:43], s66 offen offset:1024 sc1 lds
    v_exp_f32 v53, v53
    v_exp_f32 v54, v54
    v_exp_f32 v55, v55
    v_cvt_pk_bf16_f32 v42, v52, v53
    v_cvt_pk_bf16_f32 v43, v54, v55
    v_mfma_f32_32x32x16_bf16 v[80:95], v[36:39], v[44:47], v[80:95]
    ds_read_b128 v[36:39], v199 offset:3072
    v_exp_f32 v56, v56
    buffer_load_dwordx4 v1, s[40:43], s66 offen offset:2048 sc1 lds
    v_exp_f32 v57, v57
    v_exp_f32 v58, v58
    v_exp_f32 v59, v59
    v_cvt_pk_bf16_f32 v44, v56, v57
    v_cvt_pk_bf16_f32 v45, v58, v59
    s_waitcnt lgkmcnt(4)
    v_mfma_f32_32x32x16_bf16 v[148:163], v[32:35], v[40:43], v[148:163]
    v_exp_f32 v60, v60
    buffer_load_dwordx4 v1, s[40:43], s66 offen offset:3072 sc1 lds
    v_exp_f32 v61, v61
    v_exp_f32 v62, v62
    v_exp_f32 v63, v63
    v_cvt_pk_bf16_f32 v46, v60, v61
    v_cvt_pk_bf16_f32 v47, v62, v63
    s_setprio 1
    s_waitcnt lgkmcnt(3)
    v_mfma_f32_32x32x16_bf16 v[48:63], v[24:27], v[132:135], 0
    v_exp_f32 v64, v64
    s_add_u32 m0, s79, 14464
    v_exp_f32 v65, v65
    s_mov_b32 s67, 57344
    v_exp_f32 v66, v66
    buffer_load_dwordx4 v202, s[12:15], s67 offen lds
    v_exp_f32 v67, v67
    v_cvt_pk_bf16_f32 v40, v64, v65
    v_cvt_pk_bf16_f32 v41, v66, v67
    s_waitcnt lgkmcnt(1)
    v_mfma_f32_32x32x16_bf16 v[48:63], v[28:31], v[136:139], v[48:63]
    ds_read_u8 v127, v125 offset:32
    v_exp_f32 v68, v68
    v_exp_f32 v69, v69
    v_exp_f32 v70, v70
    v_exp_f32 v71, v71
    v_cvt_pk_bf16_f32 v42, v68, v69
    v_cvt_pk_bf16_f32 v43, v70, v71
    s_waitcnt lgkmcnt(1)
    v_mfma_f32_32x32x16_bf16 v[148:163], v[36:39], v[44:47], v[148:163]
    v_exp_f32 v72, v72
    v_exp_f32 v73, v73
    v_exp_f32 v74, v74
    v_exp_f32 v75, v75
    v_cvt_pk_bf16_f32 v44, v72, v73
    v_cvt_pk_bf16_f32 v45, v74, v75
    s_setprio 0
    v_mfma_f32_32x32x16_bf16 v[80:95], v[32:35], v[40:43], v[80:95]
    ds_read_b128 v[32:35], v199 offset:6144
    v_exp_f32 v76, v76
    v_exp_f32 v77, v77
    v_exp_f32 v78, v78
    v_exp_f32 v79, v79
    s_waitcnt lgkmcnt(1)
    v_cmp_eq_u32 vcc, 0, v127
    v_cvt_pk_bf16_f32 v46, v76, v77
    v_cvt_pk_bf16_f32 v47, v78, v79
    s_cbranch_vccnz L_sp5
L_spr5:
    s_setprio 3
    v_mfma_f32_32x32x16_bf16 v[64:79], v[24:27], v[16:19], 0
    ds_read_b128 v[24:27], v199 offset:32768
    v_exp_f32 v48, v48
    v_exp_f32 v49, v49
    v_exp_f32 v50, v50
    v_exp_f32 v51, v51
    v_cvt_pk_bf16_f32 v40, v48, v49
    v_cvt_pk_bf16_f32 v41, v50, v51
    v_mfma_f32_32x32x16_bf16 v[64:79], v[28:31], v[20:23], v[64:79]
    ds_read_b128 v[28:31], v199 offset:33792
    v_exp_f32 v52, v52
    v_exp_f32 v53, v53
    v_exp_f32 v54, v54
    v_exp_f32 v55, v55
    v_cvt_pk_bf16_f32 v42, v52, v53
    v_cvt_pk_bf16_f32 v43, v54, v55
    v_mfma_f32_32x32x16_bf16 v[80:95], v[36:39], v[44:47], v[80:95]
    ds_read_b128 v[36:39], v199 offset:7168
    v_exp_f32 v56, v56
    v_exp_f32 v57, v57
    v_exp_f32 v58, v58
    v_exp_f32 v59, v59
    v_cvt_pk_bf16_f32 v44, v56, v57
    v_cvt_pk_bf16_f32 v45, v58, v59
    s_waitcnt lgkmcnt(3)
    v_mfma_f32_32x32x16_bf16 v[148:163], v[32:35], v[40:43], v[148:163]
    v_exp_f32 v60, v60
    v_exp_f32 v61, v61
    v_exp_f32 v62, v62
    v_exp_f32 v63, v63
    v_cvt_pk_bf16_f32 v46, v60, v61
    v_cvt_pk_bf16_f32 v47, v62, v63
    s_waitcnt lgkmcnt(2)
    v_mfma_f32_32x32x16_bf16 v[48:63], v[24:27], v[132:135], 0
    v_exp_f32 v64, v64
    v_exp_f32 v65, v65
    v_exp_f32 v66, v66
    v_exp_f32 v67, v67
    v_cvt_pk_bf16_f32 v40, v64, v65
    v_cvt_pk_bf16_f32 v41, v66, v67
    s_waitcnt lgkmcnt(1)
    v_mfma_f32_32x32x16_bf16 v[48:63], v[28:31], v[136:139], v[48:63]
    v_exp_f32 v68, v68
    v_exp_f32 v69, v69
    v_exp_f32 v70, v70
    v_exp_f32 v71, v71
    v_cvt_pk_bf16_f32 v42, v68, v69
    v_cvt_pk_bf16_f32 v43, v70, v71
    s_waitcnt lgkmcnt(0)
    v_mfma_f32_32x32x16_bf16 v[148:163], v[36:39], v[44:47], v[148:163]
    v_exp_f32 v72, v72
    v_exp_f32 v73, v73
    v_exp_f32 v74, v74
    v_exp_f32 v75, v75
    v_cvt_pk_bf16_f32 v44, v72, v73
    v_cvt_pk_bf16_f32 v45, v74, v75
    s_setprio 2
    v_mfma_f32_32x32x16_bf16 v[80:95], v[32:35], v[40:43], v[80:95]
    ds_read_b128 v[32:35], v199 offset:34816
    v_exp_f32 v76, v76
    v_exp_f32 v77, v77
    v_exp_f32 v78, v78
    v_exp_f32 v79, v79
    v_cvt_pk_bf16_f32 v46, v76, v77
    v_cvt_pk_bf16_f32 v47, v78, v79
    v_mfma_f32_32x32x16_bf16 v[64:79], v[24:27], v[16:19], 0
    ds_read_b128 v[24:27], v199 offset:36864
    s_waitcnt vmcnt(0)
    ds_write_b8 v124, v108 offset:40
    v_exp_f32 v48, v48
    s_add_u32 m0, s28, 131072
    v_exp_f32 v49, v49
    s_add_u32 s66, s3, 229376
    v_exp_f32 v50, v50
    buffer_load_dwordx4 v1, s[40:43], s66 offen offset:0 sc1 lds
    v_exp_f32 v51, v51
    v_cvt_pk_bf16_f32 v40, v48, v49
    v_cvt_pk_bf16_f32 v41, v50, v51
    s_cmp_lg_u32 s47, 2
    s_cbranch_scc1 L_nfc
    s_movk_i32 s57, 12288
    buffer_load_dwordx4 v[120:123], v1, s[40:43], s57 offen sc1
L_nfc:
    v_mfma_f32_32x32x16_bf16 v[64:79], v[28:31], v[20:23], v[64:79]
    ds_read_b128 v[28:31], v199 offset:37888
    v_exp_f32 v52, v52
    buffer_load_dwordx4 v1, s[40:43], s66 offen offset:1024 sc1 lds
    v_exp_f32 v53, v53
    v_exp_f32 v54, v54
    v_exp_f32 v55, v55
    v_cvt_pk_bf16_f32 v42, v52, v53
    v_cvt_pk_bf16_f32 v43, v54, v55
    v_mfma_f32_32x32x16_bf16 v[80:95], v[36:39], v[44:47], v[80:95]
    ds_read_b128 v[36:39], v199 offset:35840
    v_exp_f32 v56, v56
    buffer_load_dwordx4 v1, s[40:43], s66 offen offset:2048 sc1 lds
    v_exp_f32 v57, v57
    v_exp_f32 v58, v58
    v_exp_f32 v59, v59
    v_cvt_pk_bf16_f32 v44, v56, v57
    v_cvt_pk_bf16_f32 v45, v58, v59
    s_waitcnt lgkmcnt(4)
    v_mfma_f32_32x32x16_bf16 v[148:163], v[32:35], v[40:43], v[148:163]
    v_exp_f32 v60, v60
    buffer_load_dwordx4 v1, s[40:43], s66 offen offset:3072 sc1 lds
    v_exp_f32 v61, v61
    v_exp_f32 v62, v62
    v_exp_f32 v63, v63
    v_cvt_pk_bf16_f32 v46, v60, v61
    v_cvt_pk_bf16_f32 v47, v62, v63
    s_setprio 1
    s_waitcnt lgkmcnt(3)
    v_mfma_f32_32x32x16_bf16 v[48:63], v[24:27], v[132:135], 0
    v_exp_f32 v64, v64
    s_add_u32 m0, s79, 21632
    v_exp_f32 v65, v65
    s_mov_b32 s67, 86016
    v_exp_f32 v66, v66
    buffer_load_dwordx4 v202, s[12:15], s67 offen lds
    v_exp_f32 v67, v67
    v_cvt_pk_bf16_f32 v40, v64, v65
    v_cvt_pk_bf16_f32 v41, v66, v67
    s_waitcnt lgkmcnt(1)
    v_mfma_f32_32x32x16_bf16 v[48:63], v[28:31], v[136:139], v[48:63]
    ds_read_u8 v127, v126 offset:40
    v_exp_f32 v68, v68
    v_exp_f32 v69, v69
    v_exp_f32 v70, v70
    v_exp_f32 v71, v71
    v_cvt_pk_bf16_f32 v42, v68, v69
    v_cvt_pk_bf16_f32 v43, v70, v71
    s_waitcnt lgkmcnt(1)
    v_mfma_f32_32x32x16_bf16 v[148:163], v[36:39], v[44:47], v[148:163]
    v_exp_f32 v72, v72
    v_exp_f32 v73, v73
    v_exp_f32 v74, v74
    v_exp_f32 v75, v75
    v_cvt_pk_bf16_f32 v44, v72, v73
    v_cvt_pk_bf16_f32 v45, v74, v75
    s_setprio 0
    v_mfma_f32_32x32x16_bf16 v[80:95], v[32:35], v[40:43], v[80:95]
    ds_read_b128 v[32:35], v199 offset:38912
    v_exp_f32 v76, v76
    v_exp_f32 v77, v77
    v_exp_f32 v78, v78
    v_exp_f32 v79, v79
    s_waitcnt lgkmcnt(1)
    v_cmp_eq_u32 vcc, 0, v127
    v_cvt_pk_bf16_f32 v46, v76, v77
    v_cvt_pk_bf16_f32 v47, v78, v79
    s_cbranch_vccnz L_sp6
L_spr6:
    s_setprio 3
    v_mfma_f32_32x32x16_bf16 v[64:79], v[24:27], v[16:19], 0
    ds_read_b128 v[24:27], v200 offset:0
    v_exp_f32 v48, v48
    v_exp_f32 v49, v49
    v_exp_f32 v50, v50
    v_exp_f32 v51, v51
    v_cvt_pk_bf16_f32 v40, v48, v49
    v_cvt_pk_bf16_f32 v41, v50, v51
    v_mfma_f32_32x32x16_bf16 v[64:79], v[28:31], v[20:23], v[64:79]
    ds_read_b128 v[28:31], v200 offset:1024
    v_exp_f32 v52, v52
    v_exp_f32 v53, v53
    v_exp_f32 v54, v54
    v_exp_f32 v55, v55
    v_cvt_pk_bf16_f32 v42, v52, v53
    v_cvt_pk_bf16_f32 v43, v54, v55
    v_mfma_f32_32x32x16_bf16 v[80:95], v[36:39], v[44:47], v[80:95]
    ds_read_b128 v[36:39], v199 offset:39936
    v_exp_f32 v56, v56
    v_exp_f32 v57, v57
    v_exp_f32 v58, v58
    v_exp_f32 v59, v59
    v_cvt_pk_bf16_f32 v44, v56, v57
    v_cvt_pk_bf16_f32 v45, v58, v59
    s_waitcnt lgkmcnt(3)
    v_mfma_f32_32x32x16_bf16 v[148:163], v[32:35], v[40:43], v[148:163]
    v_exp_f32 v60, v60
    v_exp_f32 v61, v61
    v_exp_f32 v62, v62
    v_exp_f32 v63, v63
    v_cvt_pk_bf16_f32 v46, v60, v61
    v_cvt_pk_bf16_f32 v47, v62, v63
    s_waitcnt lgkmcnt(2)
    v_mfma_f32_32x32x16_bf16 v[48:63], v[24:27], v[132:135], 0
    v_exp_f32 v64, v64
    v_exp_f32 v65, v65
    v_exp_f32 v66, v66
    v_exp_f32 v67, v67
    v_cvt_pk_bf16_f32 v40, v64, v65
    v_cvt_pk_bf16_f32 v41, v66, v67
    s_waitcnt lgkmcnt(1)
    v_mfma_f32_32x32x16_bf16 v[48:63], v[28:31], v[136:139], v[48:63]
    v_exp_f32 v68, v68
    v_exp_f32 v69, v69
    v_exp_f32 v70, v70
    v_exp_f32 v71, v71
    v_cvt_pk_bf16_f32 v42, v68, v69
    v_cvt_pk_bf16_f32 v43, v70, v71
    s_waitcnt lgkmcnt(0)
    v_mfma_f32_32x32x16_bf16 v[148:163], v[36:39], v[44:47], v[148:163]
    v_exp_f32 v72, v72
    v_exp_f32 v73, v73
    v_exp_f32 v74, v74
    v_exp_f32 v75, v75
    v_cvt_pk_bf16_f32 v44, v72, v73
    v_cvt_pk_bf16_f32 v45, v74, v75
    s_setprio 2
    v_mfma_f32_32x32x16_bf16 v[80:95], v[32:35], v[40:43], v[80:95]
    ds_read_b128 v[32:35], v200 offset:2048
    v_exp_f32 v76, v76
    v_exp_f32 v77, v77
    v_exp_f32 v78, v78
    v_exp_f32 v79, v79
    v_cvt_pk_bf16_f32 v46, v76, v77
    v_cvt_pk_bf16_f32 v47, v78, v79
    v_mfma_f32_32x32x16_bf16 v[64:79], v[24:27], v[16:19], 0
    ds_read_b128 v[24:27], v200 offset:4096
    v_exp_f32 v48, v48
    v_exp_f32 v49, v49
    v_exp_f32 v50, v50
    v_exp_f32 v51, v51
    v_cvt_pk_bf16_f32 v40, v48, v49
    v_cvt_pk_bf16_f32 v41, v50, v51
    v_mfma_f32_32x32x16_bf16 v[64:79], v[28:31], v[20:23], v[64:79]
    ds_read_b128 v[28:31], v200 offset:5120
    v_exp_f32 v52, v52
    v_exp_f32 v53, v53
    v_exp_f32 v54, v54
    v_exp_f32 v55, v55
    v_cvt_pk_bf16_f32 v42, v52, v53
    v_cvt_pk_bf16_f32 v43, v54, v55
    v_mfma_f32_32x32x16_bf16 v[80:95], v[36:39], v[44:47], v[80:95]
    ds_read_b128 v[36:39], v200 offset:3072
    s_waitcnt vmcnt(0)
    s_cmp_lg_u32 s47, 2
    s_cbranch_scc1 L_chkc_r
    s_mov_b32 s71, 65536
L_chkc1:
    v_cmp_ne_u32 vcc, s46, v120
    v_cmp_ne_u32 s[74:75], s46, v121
    s_nop 0
    s_or_b64 s[74:75], vcc, s[74:75]
    v_cmp_ne_u32 vcc, s46, v122
    s_nop 0
    s_or_b64 s[74:75], vcc, s[74:75]
    v_cmp_ne_u32 vcc, s46, v123
    s_nop 0
    s_or_b64 vcc, vcc, s[74:75]
    s_cbranch_scc1 L_chkc3
L_chkc2:
    s_cmp_eq_u32 s2, 0
    s_cbranch_scc1 L_epoch
L_chkc_r:
    ds_write_b8 v124, v108 offset:48
    v_exp_f32 v56, v56
    s_add_u32 m0, s79, 28800
    v_exp_f32 v57, v57
    s_mov_b32 s67, 114688
    v_exp_f32 v58, v58
    buffer_load_dwordx4 v202, s[12:15], s67 offen lds
    v_exp_f32 v59, v59
    v_cvt_pk_bf16_f32 v44, v56, v57
    v_cvt_pk_bf16_f32 v45, v58, v59
    s_waitcnt lgkmcnt(4)
    v_mfma_f32_32x32x16_bf16 v[148:163], v[32:35], v[40:43], v[148:163]
    v_exp_f32 v60, v60
    s_add_u32 m0, s79, 35968
    v_exp_f32 v61, v61
    s_mov_b32 s67, 143360
    v_exp_f32 v62, v62
    buffer_load_dwordx4 v202, s[12:15], s67 offen lds
    v_exp_f32 v63, v63
    v_cvt_pk_bf16_f32 v46, v60, v61
    v_cvt_pk_bf16_f32 v47, v62, v63
    s_setprio 1
    s_waitcnt lgkmcnt(3)
    v_mfma_f32_32x32x16_bf16 v[48:63], v[24:27], v[132:135], 0
    v_exp_f32 v64, v64
    s_add_u32 m0, s79, 43136
    v_exp_f32 v65, v65
    s_mov_b32 s67, 172032
    v_exp_f32 v66, v66
    buffer_load_dwordx4 v202, s[12:15], s67 offen lds
    v_exp_f32 v67, v67
    v_cvt_pk_bf16_f32 v40, v64, v65
    v_cvt_pk_bf16_f32 v41, v66, v67
    s_waitcnt lgkmcnt(2)
    v_mfma_f32_32x32x16_bf16 v[48:63], v[28:31], v[136:139], v[48:63]
    v_exp_f32 v68, v68
    s_add_u32 m0, s79, 50304
    v_exp_f32 v69, v69
    s_mov_b32 s67, 200704
    v_exp_f32 v70, v70
    buffer_load_dwordx4 v202, s[12:15], s67 offen lds
    v_exp_f32 v71, v71
    v_cvt_pk_bf16_f32 v42, v68, v69
    v_cvt_pk_bf16_f32 v43, v70, v71
    s_waitcnt lgkmcnt(1)
    v_mfma_f32_32x32x16_bf16 v[148:163], v[36:39], v[44:47], v[148:163]
    ds_read_u8 v127, v126 offset:48
    v_exp_f32 v72, v72
    s_add_u32 m0, s79, 57472
    v_exp_f32 v73, v73
    s_mov_b32 s67, 229376
    v_exp_f32 v74, v74
    buffer_load_dwordx4 v202, s[12:15], s67 offen lds
    v_exp_f32 v75, v75
    v_cvt_pk_bf16_f32 v44, v72, v73
    v_cvt_pk_bf16_f32 v45, v74, v75
    s_setprio 0
    v_mfma_f32_32x32x16_bf16 v[80:95], v[32:35], v[40:43], v[80:95]
    ds_read_b128 v[32:35], v200 offset:6144
    v_exp_f32 v76, v76
    v_exp_f32 v77, v77
    v_exp_f32 v78, v78
    v_exp_f32 v79, v79
    s_waitcnt lgkmcnt(1)
    v_cmp_eq_u32 vcc, 0, v127
    v_cvt_pk_bf16_f32 v46, v76, v77
    v_cvt_pk_bf16_f32 v47, v78, v79
    s_cbranch_vccnz L_sp7
L_spr7:
    s_setprio 3
    v_mfma_f32_32x32x16_bf16 v[64:79], v[24:27], v[16:19], 0
    ds_read_b128 v[24:27], v200 offset:32768
    v_exp_f32 v48, v48
    s_add_u32 m0, s79, 64640
    v_exp_f32 v49, v49
    s_mov_b32 s67, 258048
    v_exp_f32 v50, v50
    buffer_load_dwordx4 v202, s[12:15], s67 offen lds
    v_exp_f32 v51, v51
    v_cvt_pk_bf16_f32 v40, v48, v49
    v_cvt_pk_bf16_f32 v41, v50, v51
    v_mfma_f32_32x32x16_bf16 v[64:79], v[28:31], v[20:23], v[64:79]
    ds_read_b128 v[28:31], v200 offset:33792
    v_exp_f32 v52, v52
    s_add_u32 m0, s79, 71808
    v_exp_f32 v53, v53
    s_mov_b32 s67, 286720
    v_exp_f32 v54, v54
    buffer_load_dwordx4 v202, s[12:15], s67 offen lds
    v_exp_f32 v55, v55
    v_cvt_pk_bf16_f32 v42, v52, v53
    v_cvt_pk_bf16_f32 v43, v54, v55
    v_mfma_f32_32x32x16_bf16 v[80:95], v[36:39], v[44:47], v[80:95]
    ds_read_b128 v[36:39], v200 offset:7168
    v_exp_f32 v56, v56
    s_add_u32 m0, s79, 78976
    v_exp_f32 v57, v57
    s_mov_b32 s67, 315392
    v_exp_f32 v58, v58
    buffer_load_dwordx4 v202, s[12:15], s67 offen lds
    v_exp_f32 v59, v59
    v_cvt_pk_bf16_f32 v44, v56, v57
    v_cvt_pk_bf16_f32 v45, v58, v59
    s_waitcnt lgkmcnt(3)
    v_mfma_f32_32x32x16_bf16 v[148:163], v[32:35], v[40:43], v[148:163]
    v_exp_f32 v60, v60
    s_add_u32 m0, s79, 86144
    v_exp_f32 v61, v61
    s_mov_b32 s67, 344064
    v_exp_f32 v62, v62
    buffer_load_dwordx4 v202, s[12:15], s67 offen lds
    v_exp_f32 v63, v63
    v_cvt_pk_bf16_f32 v46, v60, v61
    v_cvt_pk_bf16_f32 v47, v62, v63
    s_waitcnt lgkmcnt(2)
    v_mfma_f32_32x32x16_bf16 v[48:63], v[24:27], v[132:135], 0
    ds_read_b128 v[164:167], v200 offset:36864
    v_exp_f32 v64, v64
    s_add_u32 m0, s79, 93312
    v_exp_f32 v65, v65
    s_mov_b32 s67, 372736
    v_exp_f32 v66, v66
    buffer_load_dwordx4 v202, s[12:15], s67 offen lds
    v_exp_f32 v67, v67
    v_cvt_pk_bf16_f32 v40, v64, v65
    v_cvt_pk_bf16_f32 v41, v66, v67
    s_waitcnt lgkmcnt(2)
    v_mfma_f32_32x32x16_bf16 v[48:63], v[28:31], v[136:139], v[48:63]
    ds_read_b128 v[168:171], v200 offset:37888
    v_exp_f32 v68, v68
    v_exp_f32 v69, v69
    v_exp_f32 v70, v70
    v_exp_f32 v71, v71
    v_cvt_pk_bf16_f32 v42, v68, v69
    v_cvt_pk_bf16_f32 v43, v70, v71
    s_cmp_lt_u32 s47, 4
    s_cbranch_scc1 L_nz
    buffer_load_dwordx4 v[248:251], v209, s[40:43], s31 offen sc1
    buffer_load_dwordx4 v[252:255], v209, s[40:43], s31 offen offset:64 sc1
L_nz:
    s_waitcnt lgkmcnt(2)
    v_mfma_f32_32x32x16_bf16 v[148:163], v[36:39], v[44:47], v[148:163]
    ds_read_b128 v[172:175], v200 offset:38912
    v_exp_f32 v72, v72
    v_exp_f32 v73, v73
    v_exp_f32 v74, v74
    v_exp_f32 v75, v75
    v_cvt_pk_bf16_f32 v44, v72, v73
    v_cvt_pk_bf16_f32 v45, v74, v75
    s_setprio 2
    v_mfma_f32_32x32x16_bf16 v[80:95], v[32:35], v[40:43], v[80:95]
    ds_read_b128 v[32:35], v200 offset:34816
    v_exp_f32 v76, v76
    v_exp_f32 v77, v77
    v_exp_f32 v78, v78
    v_exp_f32 v79, v79
    v_cvt_pk_bf16_f32 v46, v76, v77
    v_cvt_pk_bf16_f32 v47, v78, v79
    s_waitcnt lgkmcnt(3)
    v_mfma_f32_32x32x16_bf16 v[64:79], v[164:167], v[132:135], 0
    ds_read_b128 v[176:179], v200 offset:39936
    v_exp_f32 v48, v48
    v_exp_f32 v49, v49
    v_exp_f32 v50, v50
    v_exp_f32 v51, v51
    v_cvt_pk_bf16_f32 v40, v48, v49
    v_cvt_pk_bf16_f32 v41, v50, v51
    s_waitcnt lgkmcnt(3)
    v_mfma_f32_32x32x16_bf16 v[64:79], v[168:171], v[136:139], v[64:79]
    v_exp_f32 v52, v52
    v_exp_f32 v53, v53
    v_exp_f32 v54, v54
    v_exp_f32 v55, v55
    v_cvt_pk_bf16_f32 v42, v52, v53
    v_cvt_pk_bf16_f32 v43, v54, v55
    v_mfma_f32_32x32x16_bf16 v[80:95], v[36:39], v[44:47], v[80:95]
    ds_read_b128 v[36:39], v200 offset:35840
    v_exp_f32 v56, v56
    v_exp_f32 v57, v57
    v_exp_f32 v58, v58
    v_exp_f32 v59, v59
    v_cvt_pk_bf16_f32 v44, v56, v57
    v_cvt_pk_bf16_f32 v45, v58, v59
    ds_write_b8 v124, v108 offset:56
    s_waitcnt lgkmcnt(3)
    v_mfma_f32_32x32x16_bf16 v[148:163], v[32:35], v[40:43], v[148:163]
    v_exp_f32 v60, v60
    v_exp_f32 v61, v61
    v_exp_f32 v62, v62
    v_exp_f32 v63, v63
    v_cvt_pk_bf16_f32 v46, v60, v61
    v_cvt_pk_bf16_f32 v47, v62, v63
    s_setprio 1
    v_mfma_f32_32x32x16_bf16 v[48:63], v[24:27], v[16:19], 0
    v_exp_f32 v64, v64
    v_exp_f32 v65, v65
    v_exp_f32 v66, v66
    v_exp_f32 v67, v67
    v_cvt_pk_bf16_f32 v40, v64, v65
    v_cvt_pk_bf16_f32 v41, v66, v67
    v_mfma_f32_32x32x16_bf16 v[48:63], v[28:31], v[20:23], v[48:63]
    v_exp_f32 v68, v68
    v_exp_f32 v69, v69
    v_exp_f32 v70, v70
    v_exp_f32 v71, v71
    v_cvt_pk_bf16_f32 v42, v68, v69
    v_cvt_pk_bf16_f32 v43, v70, v71
    s_waitcnt lgkmcnt(1)
    v_mfma_f32_32x32x16_bf16 v[148:163], v[36:39], v[44:47], v[148:163]
    v_exp_f32 v72, v72
    v_exp_f32 v73, v73
    v_exp_f32 v74, v74
    v_exp_f32 v75, v75
    v_cvt_pk_bf16_f32 v44, v72, v73
    v_cvt_pk_bf16_f32 v45, v74, v75
    s_setprio 0
    v_mfma_f32_32x32x16_bf16 v[148:163], v[172:175], v[40:43], v[148:163]
    v_exp_f32 v76, v76
    v_exp_f32 v77, v77
    v_exp_f32 v78, v78
    v_exp_f32 v79, v79
    v_cvt_pk_bf16_f32 v46, v76, v77
    v_cvt_pk_bf16_f32 v47, v78, v79
    s_setprio 0
    s_cmp_lt_u32 s47, 4
    s_cbranch_scc1 L_np
    s_setprio 3
L_np:
    v_mfma_f32_32x32x16_bf16 v[64:79], v[164:167], v[16:19], 0
    v_exp_f32 v48, v48
    v_exp_f32 v49, v49
    v_exp_f32 v50, v50
    v_exp_f32 v51, v51
    v_cvt_pk_bf16_f32 v40, v48, v49
    v_cvt_pk_bf16_f32 v41, v50, v51
    v_mfma_f32_32x32x16_bf16 v[64:79], v[168:171], v[20:23], v[64:79]
    v_exp_f32 v52, v52
    v_exp_f32 v53, v53
    v_exp_f32 v54, v54
    v_exp_f32 v55, v55
    v_cvt_pk_bf16_f32 v42, v52, v53
    v_cvt_pk_bf16_f32 v43, v54, v55
    v_mfma_f32_32x32x16_bf16 v[148:163], v[176:179], v[44:47], v[148:163]
    ds_read_u8 v127, v125 offset:56
    v_exp_f32 v56, v56
    v_exp_f32 v57, v57
    v_exp_f32 v58, v58
    v_exp_f32 v59, v59
    v_cvt_pk_bf16_f32 v44, v56, v57
    v_cvt_pk_bf16_f32 v45, v58, v59
    v_mfma_f32_32x32x16_bf16 v[80:95], v[32:35], v[40:43], v[80:95]
    v_exp_f32 v60, v60
    v_exp_f32 v61, v61
    v_exp_f32 v62, v62
    v_exp_f32 v63, v63
    s_waitcnt lgkmcnt(0)
    v_cmp_eq_u32 vcc, 0, v127
    v_cvt_pk_bf16_f32 v46, v60, v61
    v_cvt_pk_bf16_f32 v47, v62, v63
    s_cbranch_vccnz L_sp8
L_spr8:
    ds_write_b128 v181, v[148:151] offset:0
    v_exp_f32 v64, v64
    v_exp_f32 v65, v65
    v_exp_f32 v66, v66
    v_exp_f32 v67, v67
    v_cvt_pk_bf16_f32 v40, v64, v65
    v_cvt_pk_bf16_f32 v41, v66, v67
    ds_write_b128 v181, v[152:155] offset:1024
    v_exp_f32 v68, v68
    v_exp_f32 v69, v69
    v_exp_f32 v70, v70
    v_exp_f32 v71, v71
    v_cvt_pk_bf16_f32 v42, v68, v69
    v_cvt_pk_bf16_f32 v43, v70, v71
    ds_write_b128 v181, v[156:159] offset:2048
    v_mfma_f32_32x32x16_bf16 v[80:95], v[36:39], v[44:47], v[80:95]
    v_exp_f32 v72, v72
    v_exp_f32 v73, v73
    v_exp_f32 v74, v74
    v_exp_f32 v75, v75
    v_cvt_pk_bf16_f32 v44, v72, v73
    v_cvt_pk_bf16_f32 v45, v74, v75
    ds_write_b128 v181, v[160:163] offset:3072
    v_mfma_f32_32x32x16_bf16 v[80:95], v[172:175], v[40:43], v[80:95]
    v_exp_f32 v76, v76
    v_exp_f32 v77, v77
    v_exp_f32 v78, v78
    v_exp_f32 v79, v79
    v_cvt_pk_bf16_f32 v46, v76, v77
    v_cvt_pk_bf16_f32 v47, v78, v79
    s_nop 1
    v_mfma_f32_32x32x16_bf16 v[80:95], v[176:179], v[44:47], v[80:95]
    s_setprio 0
    s_mov_b32 s59, 0x5f800000
    v_mov_b64 v[100:101], 0
    v_mov_b64 v[102:103], 0
    s_and_b32 s58, s47, 1
    s_mul_i32 s58, s58, 768
    s_add_u32 s58, s58, 100480
    v_add_u32 v99, s58, v1
    s_cmp_lt_u32 s47, 4
    s_cbranch_scc1 L_mA
    ds_write_b128 v99, v[100:103]
    s_nop 0
    ds_write_b128 v203, v[80:83] offset:0
    ds_write_b128 v203, v[84:87] offset:1024
    ds_write_b128 v203, v[88:91] offset:2048
    ds_write_b128 v203, v[92:95] offset:3072
L_mA:
    s_nop 1
    v_add_f32 v98, v92, v160
    v_cmp_nle_f32 vcc, v98, s59
    s_nop 1
    v_mov_b32 v98, vcc_hi
    ds_write_b32 v204, v98
    s_waitcnt vmcnt(0) lgkmcnt(0)
    s_barrier
    ds_read_b32 v98, v205
    s_cbranch_scc0 L_mB
    ds_read_b128 v[60:63], v203 offset:3072
    ds_read_b128 v[76:79], v182 offset:3072
    ds_read_b128 v[176:179], v182 offset:19456
    ds_read_b128 v[48:51], v203 offset:0
    ds_read_b128 v[64:67], v182 offset:0
    ds_read_b128 v[164:167], v182 offset:16384
    ds_read_b128 v[52:55], v203 offset:1024
    ds_read_b128 v[68:71], v182 offset:1024
    ds_read_b128 v[168:171], v182 offset:17408
    ds_read_b128 v[56:59], v203 offset:2048
    ds_read_b128 v[72:75], v182 offset:2048
    ds_read_b128 v[172:175], v182 offset:18432
    s_setprio 3
    s_waitcnt lgkmcnt(12)
    v_cmp_lt_u32 vcc, s70, v98
    s_nop 0
    s_cbranch_vccnz L_fallback
    s_waitcnt lgkmcnt(11)
    v_pk_add_f32 v[92:93], v[92:93], v[60:61]
    v_pk_add_f32 v[94:95], v[94:95], v[62:63]
    s_waitcnt lgkmcnt(9)
    v_pk_add_f32 v[76:77], v[76:77], v[176:177]
    v_pk_add_f32 v[78:79], v[78:79], v[178:179]
    v_pk_add_f32 v[92:93], v[92:93], v[76:77]
    v_pk_add_f32 v[94:95], v[94:95], v[78:79]
    v_mov_b32 v96, v92
    v_mov_b32 v97, v92
    s_waitcnt lgkmcnt(8)
    v_pk_add_f32 v[80:81], v[80:81], v[48:49]
    v_pk_add_f32 v[82:83], v[82:83], v[50:51]
    s_waitcnt lgkmcnt(6)
    v_pk_add_f32 v[64:65], v[64:65], v[164:165]
    v_pk_add_f32 v[66:67], v[66:67], v[166:167]
    v_pk_add_f32 v[80:81], v[80:81], v[64:65]
    v_pk_add_f32 v[82:83], v[82:83], v[66:67]
    v_permlane32_swap_b32 v96, v97
    v_rcp_f32 v96, v97
    s_waitcnt lgkmcnt(5)
    v_pk_add_f32 v[84:85], v[84:85], v[52:53]
    v_pk_add_f32 v[86:87], v[86:87], v[54:55]
    s_waitcnt lgkmcnt(3)
    v_pk_add_f32 v[68:69], v[68:69], v[168:169]
    v_pk_add_f32 v[70:71], v[70:71], v[170:171]
    v_pk_add_f32 v[84:85], v[84:85], v[68:69]
    v_pk_add_f32 v[86:87], v[86:87], v[70:71]
    s_waitcnt lgkmcnt(2)
    v_pk_add_f32 v[88:89], v[88:89], v[56:57]
    v_pk_add_f32 v[90:91], v[90:91], v[58:59]
    s_waitcnt lgkmcnt(0)
    v_pk_add_f32 v[72:73], v[72:73], v[172:173]
    v_pk_add_f32 v[74:75], v[74:75], v[174:175]
    v_pk_add_f32 v[88:89], v[88:89], v[72:73]
    v_pk_add_f32 v[90:91], v[90:91], v[74:75]
    v_pk_mul_f32 v[80:81], v[80:81], v[96:97] op_sel_hi:[1,0]
    v_pk_mul_f32 v[82:83], v[82:83], v[96:97] op_sel_hi:[1,0]
    v_pk_mul_f32 v[84:85], v[84:85], v[96:97] op_sel_hi:[1,0]
    v_pk_mul_f32 v[86:87], v[86:87], v[96:97] op_sel_hi:[1,0]
    v_cvt_pk_bf16_f32 v40, v80, v81
    v_cvt_pk_bf16_f32 v41, v82, v83
    v_cvt_pk_bf16_f32 v42, v84, v85
    v_cvt_pk_bf16_f32 v43, v86, v87
    buffer_store_dwordx4 v[40:43], v1, s[40:43], s27 offen offset:0 sc1
    v_pk_mul_f32 v[88:89], v[88:89], v[96:97] op_sel_hi:[1,0]
    v_pk_mul_f32 v[90:91], v[90:91], v[96:97] op_sel_hi:[1,0]
    v_pk_mul_f32 v[92:93], v[92:93], v[96:97] op_sel_hi:[1,0]
    v_pk_mul_f32 v[94:95], v[94:95], v[96:97] op_sel_hi:[1,0]
    v_cvt_pk_bf16_f32 v44, v88, v89
    v_cvt_pk_bf16_f32 v45, v90, v91
    v_cvt_pk_bf16_f32 v46, v92, v93
    v_cvt_pk_bf16_f32 v47, v94, v95
    s_mov_b32 exec_lo, 0
    v_mov_b64 v[46:47], 0
    s_mov_b32 exec_lo, -1
    buffer_store_dwordx4 v[44:47], v1, s[40:43], s27 offen offset:1024 sc1
    s_setprio 0
    s_barrier
    v_bfe_u32 v96, v0, 2, 2
    v_lshrrev_b32 v97, 5, v0
    v_lshl_add_u32 v96, v96, 1, v97
    v_mul_u32_u24 v96, 224, v96
    v_bfe_u32 v98, v0, 4, 1
    v_lshl_add_u32 v96, v98, 5, v96
    v_and_b32 v98, 3, v0
    v_lshl_add_u32 v96, v98, 3, v96
    s_lshl_b32 s59, s55, 6
    v_add_u32 v2, s59, v96
    v_mul_u32_u24 v99, 1344, v97
    v_add_u32 v3, v99, v2
    v_add_u32 v9, 50176, v2
    v_add_u32 v10, 50176, v3
    ds_read_b64_tr_b16 v[112:113], v2 offset:128
    ds_read_b64_tr_b16 v[114:115], v2 offset:1920
    ds_read_b64_tr_b16 v[116:117], v2 offset:3712
    ds_read_b64_tr_b16 v[118:119], v2 offset:5504
    ds_read_b64_tr_b16 v[120:121], v3 offset:5728
    ds_read_b64_tr_b16 v[122:123], v3 offset:7520
    ds_read_b64_tr_b16 v[124:125], v3 offset:9312
    ds_read_b64_tr_b16 v[126:127], v3 offset:11104
    ds_read_b64_tr_b16 v[128:129], v2 offset:12672
    ds_read_b64_tr_b16 v[130:131], v2 offset:14464
    ds_read_b64_tr_b16 v[132:133], v2 offset:16256
    ds_read_b64_tr_b16 v[134:135], v2 offset:18048
    ds_read_b64_tr_b16 v[136:137], v3 offset:18272
    ds_read_b64_tr_b16 v[138:139], v3 offset:20064
    ds_read_b64_tr_b16 v[140:141], v3 offset:21856
    ds_read_b64_tr_b16 v[142:143], v3 offset:23648
    ds_read_b64_tr_b16 v[144:145], v2 offset:25216
    ds_read_b64_tr_b16 v[146:147], v2 offset:27008
    ds_read_b64_tr_b16 v[148:149], v2 offset:28800
    ds_read_b64_tr_b16 v[150:151], v2 offset:30592
    ds_read_b64_tr_b16 v[152:153], v3 offset:30816
    ds_read_b64_tr_b16 v[154:155], v3 offset:32608
    ds_read_b64_tr_b16 v[156:157], v3 offset:34400
    ds_read_b64_tr_b16 v[158:159], v3 offset:36192
    ds_read_b64_tr_b16 v[160:161], v2 offset:37760
    ds_read_b64_tr_b16 v[162:163], v2 offset:39552
    ds_read_b64_tr_b16 v[164:165], v2 offset:41344
    ds_read_b64_tr_b16 v[166:167], v2 offset:43136
    ds_read_b64_tr_b16 v[168:169], v3 offset:43360
    ds_read_b64_tr_b16 v[170:171], v3 offset:45152
    ds_read_b64_tr_b16 v[172:173], v3 offset:46944
    ds_read_b64_tr_b16 v[174:175], v3 offset:48736
    ds_read_b64_tr_b16 v[176:177], v9 offset:128
    ds_read_b64_tr_b16 v[178:179], v9 offset:1920
    ds_read_b64_tr_b16 v[180:181], v9 offset:3712
    ds_read_b64_tr_b16 v[182:183], v9 offset:5504
    ds_read_b64_tr_b16 v[184:185], v10 offset:5728
    ds_read_b64_tr_b16 v[186:187], v10 offset:7520
    ds_read_b64_tr_b16 v[188:189], v10 offset:9312
    ds_read_b64_tr_b16 v[190:191], v10 offset:11104
    ds_read_b64_tr_b16 v[192:193], v9 offset:12672
    ds_read_b64_tr_b16 v[194:195], v9 offset:14464
    ds_read_b64_tr_b16 v[196:197], v9 offset:16256
    ds_read_b64_tr_b16 v[198:199], v9 offset:18048
    ds_read_b64_tr_b16 v[200:201], v10 offset:18272
    ds_read_b64_tr_b16 v[202:203], v10 offset:20064
    ds_read_b64_tr_b16 v[204:205], v10 offset:21856
    ds_read_b64_tr_b16 v[206:207], v10 offset:23648
    ds_read_b64_tr_b16 v[208:209], v9 offset:25216
    ds_read_b64_tr_b16 v[210:211], v9 offset:27008
    ds_read_b64_tr_b16 v[212:213], v9 offset:28800
    ds_read_b64_tr_b16 v[214:215], v9 offset:30592
    ds_read_b64_tr_b16 v[216:217], v10 offset:30816
    ds_read_b64_tr_b16 v[218:219], v10 offset:32608
    ds_read_b64_tr_b16 v[220:221], v10 offset:34400
    ds_read_b64_tr_b16 v[222:223], v10 offset:36192
    ds_read_b64_tr_b16 v[224:225], v9 offset:37760
    ds_read_b64_tr_b16 v[226:227], v9 offset:39552
    ds_read_b64_tr_b16 v[228:229], v9 offset:41344
    ds_read_b64_tr_b16 v[230:231], v9 offset:43136
    ds_read_b64_tr_b16 v[232:233], v10 offset:43360
    ds_read_b64_tr_b16 v[234:235], v10 offset:45152
    ds_read_b64_tr_b16 v[236:237], v10 offset:46944
    ds_read_b64_tr_b16 v[238:239], v10 offset:48736
    v_mov_b32 v4, 0
    v_add_u32 v5, 131072, v1
    v_and_b32 v99, 31, v0
    v_mul_u32_u24 v99, 1792, v99
    v_lshl_add_u32 v8, v97, 4, v99
    s_mul_i32 s57, s50, 57344
    s_mul_i32 s58, s51, 224
    s_add_u32 s57, s57, s58
    s_add_u32 s57, s57, s59
    s_waitcnt lgkmcnt(0)
    s_barrier
    ds_read_b128 v[16:19], v5 offset:0
    ds_read_b128 v[20:23], v5 offset:1024
    ds_read_b128 v[24:27], v5 offset:2048
    ds_read_b128 v[28:31], v5 offset:3072
    ds_read_b128 v[32:35], v5 offset:4096
    ds_read_b128 v[36:39], v5 offset:5120
    ds_read_b128 v[40:43], v5 offset:6144
    ds_read_b128 v[44:47], v5 offset:7168
    ds_read_b32 v96, v4 offset:68
    s_waitcnt lgkmcnt(8)
    v_mfma_f32_32x32x16_bf16 v[48:63], v[112:115], v[16:19], 0
    s_waitcnt lgkmcnt(7)
    v_mfma_f32_32x32x16_bf16 v[48:63], v[116:119], v[20:23], v[48:63]
    s_waitcnt lgkmcnt(6)
    v_mfma_f32_32x32x16_bf16 v[48:63], v[120:123], v[24:27], v[48:63]
    s_waitcnt lgkmcnt(5)
    v_mfma_f32_32x32x16_bf16 v[48:63], v[124:127], v[28:31], v[48:63]
    s_waitcnt lgkmcnt(0)
    v_cmp_ne_u32 vcc, -1, v96
    s_nop 0
    s_cbranch_vccz L_or1
L_os1:
    ds_read_b32 v96, v4 offset:68
    s_waitcnt lgkmcnt(0)
    v_cmp_ne_u32 vcc, -1, v96
    s_nop 0
    s_cbranch_vccnz L_os1
L_or1:
    ds_read_b128 v[64:67], v5 offset:8192
    ds_read_b128 v[68:71], v5 offset:9216
    v_mfma_f32_32x32x16_bf16 v[48:63], v[128:131], v[32:35], v[48:63]
    ds_read_b128 v[72:75], v5 offset:10240
    ds_read_b128 v[76:79], v5 offset:11264
    v_mfma_f32_32x32x16_bf16 v[48:63], v[132:135], v[36:39], v[48:63]
    ds_read_b128 v[80:83], v5 offset:12288
    ds_read_b128 v[84:87], v5 offset:13312
    v_mfma_f32_32x32x16_bf16 v[48:63], v[136:139], v[40:43], v[48:63]
    ds_read_b128 v[88:91], v5 offset:14336
    ds_read_b128 v[92:95], v5 offset:15360
    v_mfma_f32_32x32x16_bf16 v[48:63], v[140:143], v[44:47], v[48:63]
    ds_read_b32 v96, v4 offset:72
    s_waitcnt lgkmcnt(8)
    v_mfma_f32_32x32x16_bf16 v[48:63], v[144:147], v[64:67], v[48:63]
    s_waitcnt lgkmcnt(7)
    v_mfma_f32_32x32x16_bf16 v[48:63], v[148:151], v[68:71], v[48:63]
    s_waitcnt lgkmcnt(6)
    v_mfma_f32_32x32x16_bf16 v[48:63], v[152:155], v[72:75], v[48:63]
    s_waitcnt lgkmcnt(5)
    v_mfma_f32_32x32x16_bf16 v[48:63], v[156:159], v[76:79], v[48:63]
    s_waitcnt lgkmcnt(0)
    v_cmp_ne_u32 vcc, -1, v96
    s_nop 0
    s_cbranch_vccz L_or2
L_os2:
    ds_read_b32 v96, v4 offset:72
    s_waitcnt lgkmcnt(0)
    v_cmp_ne_u32 vcc, -1, v96
    s_nop 0
    s_cbranch_vccnz L_os2
L_or2:
    ds_read_b128 v[16:19], v5 offset:16384
    ds_read_b128 v[20:23], v5 offset:17408
    v_mfma_f32_32x32x16_bf16 v[48:63], v[160:163], v[80:83], v[48:63]
    ds_read_b128 v[24:27], v5 offset:18432
    ds_read_b128 v[28:31], v5 offset:19456
    v_mfma_f32_32x32x16_bf16 v[48:63], v[164:167], v[84:87], v[48:63]
    ds_read_b128 v[32:35], v5 offset:20480
    ds_read_b128 v[36:39], v5 offset:21504
    v_mfma_f32_32x32x16_bf16 v[48:63], v[168:171], v[88:91], v[48:63]
    ds_read_b128 v[40:43], v5 offset:22528
    ds_read_b128 v[44:47], v5 offset:23552
    v_mfma_f32_32x32x16_bf16 v[48:63], v[172:175], v[92:95], v[48:63]
    ds_read_b32 v96, v4 offset:76
    s_waitcnt lgkmcnt(8)
    v_mfma_f32_32x32x16_bf16 v[48:63], v[176:179], v[16:19], v[48:63]
    s_waitcnt lgkmcnt(7)
    v_mfma_f32_32x32x16_bf16 v[48:63], v[180:183], v[20:23], v[48:63]
    s_waitcnt lgkmcnt(6)
    v_mfma_f32_32x32x16_bf16 v[48:63], v[184:187], v[24:27], v[48:63]
    s_waitcnt lgkmcnt(5)
    v_mfma_f32_32x32x16_bf16 v[48:63], v[188:191], v[28:31], v[48:63]
    s_waitcnt lgkmcnt(0)
    v_cmp_ne_u32 vcc, -1, v96
    s_nop 0
    s_cbranch_vccz L_or3
L_os3:
    ds_read_b32 v96, v4 offset:76
    s_waitcnt lgkmcnt(0)
    v_cmp_ne_u32 vcc, -1, v96
    s_nop 0
    s_cbranch_vccnz L_os3
L_or3:
    ds_read_b128 v[64:67], v5 offset:24576
    ds_read_b128 v[68:71], v5 offset:25600
    v_mfma_f32_32x32x16_bf16 v[48:63], v[192:195], v[32:35], v[48:63]
    ds_read_b128 v[72:75], v5 offset:26624
    ds_read_b128 v[76:79], v5 offset:27648
    v_mfma_f32_32x32x16_bf16 v[48:63], v[196:199], v[36:39], v[48:63]
    ds_read_b128 v[80:83], v5 offset:28672
    ds_read_b128 v[84:87], v5 offset:29696
    v_mfma_f32_32x32x16_bf16 v[48:63], v[200:203], v[40:43], v[48:63]
    ds_read_b128 v[88:91], v5 offset:30720
    ds_read_b128 v[92:95], v5 offset:31744
    v_mfma_f32_32x32x16_bf16 v[48:63], v[204:207], v[44:47], v[48:63]
    s_waitcnt lgkmcnt(7)
    v_mfma_f32_32x32x16_bf16 v[48:63], v[208:211], v[64:67], v[48:63]
    s_waitcnt lgkmcnt(6)
    v_mfma_f32_32x32x16_bf16 v[48:63], v[212:215], v[68:71], v[48:63]
    s_waitcnt lgkmcnt(5)
    v_mfma_f32_32x32x16_bf16 v[48:63], v[216:219], v[72:75], v[48:63]
    s_waitcnt lgkmcnt(4)
    v_mfma_f32_32x32x16_bf16 v[48:63], v[220:223], v[76:79], v[48:63]
    s_waitcnt lgkmcnt(3)
    v_mfma_f32_32x32x16_bf16 v[48:63], v[224:227], v[80:83], v[48:63]
    s_waitcnt lgkmcnt(2)
    v_mfma_f32_32x32x16_bf16 v[48:63], v[228:231], v[84:87], v[48:63]
    s_waitcnt lgkmcnt(1)
    v_mfma_f32_32x32x16_bf16 v[48:63], v[232:235], v[88:91], v[48:63]
    s_waitcnt lgkmcnt(0)
    v_mfma_f32_32x32x16_bf16 v[48:63], v[236:239], v[92:95], v[48:63]
    s_nop 11
    v_cvt_pk_bf16_f32 v16, v48, v49
    v_cvt_pk_bf16_f32 v17, v50, v51
    v_cvt_pk_bf16_f32 v18, v52, v53
    v_cvt_pk_bf16_f32 v19, v54, v55
    s_nop 0
    v_permlane32_swap_b32 v16, v18
    v_permlane32_swap_b32 v17, v19
    buffer_store_dwordx4 v[16:19], v8, s[36:39], s57 offen offset:0
    s_cmp_eq_u32 s55, 3
    s_cbranch_scc1 L_ost
    v_cvt_pk_bf16_f32 v20, v56, v57
    v_cvt_pk_bf16_f32 v21, v58, v59
    v_cvt_pk_bf16_f32 v22, v60, v61
    v_cvt_pk_bf16_f32 v23, v62, v63
    s_nop 0
    v_permlane32_swap_b32 v20, v22
    v_permlane32_swap_b32 v21, v23
    buffer_store_dwordx4 v[20:23], v8, s[36:39], s57 offen offset:32
L_ost:
    s_endpgm
L_mB:
    s_waitcnt lgkmcnt(0)
    v_cmp_lt_u32 vcc, s70, v98
    s_nop 0
    s_cbranch_vccnz L_fallback
    s_mul_i32 s62, s50, 28672
    s_add_u32 s62, s62, 896
    v_lshlrev_b32 v16, 16, v240
    v_and_b32 v17, 0xffff0000, v240
    v_lshlrev_b32 v18, 16, v241
    v_and_b32 v19, 0xffff0000, v241
    v_lshlrev_b32 v20, 16, v242
    v_and_b32 v21, 0xffff0000, v242
    v_lshlrev_b32 v22, 16, v243
    v_and_b32 v23, 0xffff0000, v243
    v_lshlrev_b32 v24, 16, v244
    v_and_b32 v25, 0xffff0000, v244
    v_lshlrev_b32 v26, 16, v245
    v_and_b32 v27, 0xffff0000, v245
    v_lshlrev_b32 v28, 16, v246
    v_and_b32 v29, 0xffff0000, v246
    v_lshlrev_b32 v30, 16, v247
    v_and_b32 v31, 0xffff0000, v247
    v_lshlrev_b32 v32, 16, v248
    v_lshlrev_b32 v33, 16, v252
    v_and_b32 v34, 0xffff0000, v248
    v_and_b32 v35, 0xffff0000, v252
    v_lshlrev_b32 v36, 16, v249
    v_lshlrev_b32 v37, 16, v253
    v_and_b32 v38, 0xffff0000, v249
    v_and_b32 v39, 0xffff0000, v253
    v_lshlrev_b32 v40, 16, v250
    v_lshlrev_b32 v41, 16, v254
    v_and_b32 v42, 0xffff0000, v250
    v_and_b32 v43, 0xffff0000, v254
    v_lshlrev_b32 v44, 16, v251
    v_lshlrev_b32 v45, 16, v255
    v_and_b32 v46, 0xffff0000, v251
    v_and_b32 v47, 0xffff0000, v255
    v_pk_mul_f32 v[32:33], v[32:33], v[16:17]
    v_pk_mul_f32 v[34:35], v[34:35], v[18:19]
    v_pk_mul_f32 v[36:37], v[36:37], v[20:21]
    v_pk_mul_f32 v[38:39], v[38:39], v[22:23]
    v_pk_mul_f32 v[40:41], v[40:41], v[24:25]
    v_pk_mul_f32 v[42:43], v[42:43], v[26:27]
    v_pk_mul_f32 v[44:45], v[44:45], v[28:29]
    v_pk_mul_f32 v[46:47], v[46:47], v[30:31]
    v_cvt_pk_bf16_f32 v56, v32, v33
    v_cvt_pk_bf16_f32 v57, v34, v35
    v_cvt_pk_bf16_f32 v58, v36, v37
    v_cvt_pk_bf16_f32 v59, v38, v39
    v_cvt_pk_bf16_f32 v60, v40, v41
    v_cvt_pk_bf16_f32 v61, v42, v43
    v_cvt_pk_bf16_f32 v62, v44, v45
    v_cvt_pk_bf16_f32 v63, v46, v47
    s_barrier
    buffer_store_dword v56, v210, s[36:39], s62 offen offset:0
    buffer_store_dword v57, v210, s[36:39], s62 offen offset:1792
    s_add_u32 s62, s62, 3584
    buffer_store_dword v58, v210, s[36:39], s62 offen offset:0
    buffer_store_dword v59, v210, s[36:39], s62 offen offset:1792
    s_add_u32 s62, s62, 3584
    buffer_store_dword v60, v210, s[36:39], s62 offen offset:0
    buffer_store_dword v61, v210, s[36:39], s62 offen offset:1792
    s_add_u32 s62, s62, 3584
    buffer_store_dword v62, v210, s[36:39], s62 offen offset:0
    buffer_store_dword v63, v210, s[36:39], s62 offen offset:1792
    s_lshl_b32 s57, s50, 15
    s_lshl_b32 s58, s55, 11
    s_add_u32 s57, s57, s58
    s_add_u32 s57, s57, 11534336
    s_add_u32 s58, s57, 8192
    s_add_u32 s59, s57, 16384
    s_add_u32 s60, s57, 24576
    s_mov_b32 s71, 65536
    buffer_load_dwordx4 v[64:67], v1, s[40:43], s57 offen offset:0 sc1
    buffer_load_dwordx4 v[68:71], v1, s[40:43], s57 offen offset:1024 sc1
    buffer_load_dwordx4 v[72:75], v1, s[40:43], s58 offen offset:0 sc1
    buffer_load_dwordx4 v[76:79], v1, s[40:43], s58 offen offset:1024 sc1
    buffer_load_dwordx4 v[80:83], v1, s[40:43], s59 offen offset:0 sc1
    buffer_load_dwordx4 v[84:87], v1, s[40:43], s59 offen offset:1024 sc1
    buffer_load_dwordx4 v[88:91], v1, s[40:43], s60 offen offset:0 sc1
    buffer_load_dwordx4 v[92:95], v1, s[40:43], s60 offen offset:1024 sc1
    s_waitcnt vmcnt(6)
L_ochk0:
    v_max3_u32 v96, v64, v65, v66
    v_max3_u32 v97, v67, v68, v69
    v_max3_u32 v96, v70, v71, v96
    v_max_u32 v96, v96, v97
    v_cmp_eq_u32 vcc, -1, v96
    s_nop 0
    s_cbranch_vccnz L_oretry0
L_ogo0:
    ds_write_b128 v201, v[64:67] offset:0
    ds_write_b128 v201, v[68:71] offset:1024
    s_waitcnt lgkmcnt(0)
    s_barrier
    s_waitcnt vmcnt(4)
L_ochk1:
    v_max3_u32 v96, v72, v73, v74
    v_max3_u32 v97, v75, v76, v77
    v_max3_u32 v96, v78, v79, v96
    v_max_u32 v96, v96, v97
    v_cmp_eq_u32 vcc, -1, v96
    s_nop 0
    s_cbranch_vccnz L_oretry1
L_ogo1:
    ds_write_b128 v201, v[72:75] offset:8192
    ds_write_b128 v201, v[76:79] offset:9216
    ds_write_b8 v124, v108 offset:64
    s_waitcnt vmcnt(2)
L_ochk2:
    v_max3_u32 v96, v80, v81, v82
    v_max3_u32 v97, v83, v84, v85
    v_max3_u32 v96, v86, v87, v96
    v_max_u32 v96, v96, v97
    v_cmp_eq_u32 vcc, -1, v96
    s_nop 0
    s_cbranch_vccnz L_oretry2
L_ogo2:
    ds_write_b128 v201, v[80:83] offset:16384
    ds_write_b128 v201, v[84:87] offset:17408
    ds_write_b8 v124, v108 offset:68
    s_waitcnt vmcnt(0)
L_ochk3:
    v_max3_u32 v96, v88, v89, v90
    v_max3_u32 v97, v91, v92, v93
    v_max3_u32 v96, v94, v95, v96
    v_max_u32 v96, v96, v97
    v_cmp_eq_u32 vcc, -1, v96
    s_nop 0
    s_cbranch_vccnz L_oretry3
L_ogo3:
    ds_write_b128 v201, v[88:91] offset:24576
    ds_write_b128 v201, v[92:95] offset:25600
    ds_write_b8 v124, v108 offset:72
    s_waitcnt lgkmcnt(0)
L_fin:
L_end:
    s_endpgm
L_oretry0:
    s_sub_u32 s71, s71, 1
    s_cselect_b32 s71, 0, s71
    s_cbranch_scc1 L_ogo0
    buffer_load_dwordx4 v[64:67], v1, s[40:43], s57 offen offset:0 sc1
    buffer_load_dwordx4 v[68:71], v1, s[40:43], s57 offen offset:1024 sc1
    buffer_load_dwordx4 v[72:75], v1, s[40:43], s58 offen offset:0 sc1
    buffer_load_dwordx4 v[76:79], v1, s[40:43], s58 offen offset:1024 sc1
    buffer_load_dwordx4 v[80:83], v1, s[40:43], s59 offen offset:0 sc1
    buffer_load_dwordx4 v[84:87], v1, s[40:43], s59 offen offset:1024 sc1
    buffer_load_dwordx4 v[88:91], v1, s[40:43], s60 offen offset:0 sc1
    buffer_load_dwordx4 v[92:95], v1, s[40:43], s60 offen offset:1024 sc1
    s_waitcnt vmcnt(6)
    s_branch L_ochk0
L_oretry1:
    s_sub_u32 s71, s71, 1
    s_cselect_b32 s71, 0, s71
    s_cbranch_scc1 L_ogo1
    buffer_load_dwordx4 v[72:75], v1, s[40:43], s58 offen offset:0 sc1
    buffer_load_dwordx4 v[76:79], v1, s[40:43], s58 offen offset:1024 sc1
    buffer_load_dwordx4 v[80:83], v1, s[40:43], s59 offen offset:0 sc1
    buffer_load_dwordx4 v[84:87], v1, s[40:43], s59 offen offset:1024 sc1
    buffer_load_dwordx4 v[88:91], v1, s[40:43], s60 offen offset:0 sc1
    buffer_load_dwordx4 v[92:95], v1, s[40:43], s60 offen offset:1024 sc1
    s_waitcnt vmcnt(4)
    s_branch L_ochk1
L_oretry2:
    s_sub_u32 s71, s71, 1
    s_cselect_b32 s71, 0, s71
    s_cbranch_scc1 L_ogo2
    buffer_load_dwordx4 v[80:83], v1, s[40:43], s59 offen offset:0 sc1
    buffer_load_dwordx4 v[84:87], v1, s[40:43], s59 offen offset:1024 sc1
    buffer_load_dwordx4 v[88:91], v1, s[40:43], s60 offen offset:0 sc1
    buffer_load_dwordx4 v[92:95], v1, s[40:43], s60 offen offset:1024 sc1
    s_waitcnt vmcnt(2)
    s_branch L_ochk2
L_oretry3:
    s_sub_u32 s71, s71, 1
    s_cselect_b32 s71, 0, s71
    s_cbranch_scc1 L_ogo3
    buffer_load_dwordx4 v[88:91], v1, s[40:43], s60 offen offset:0 sc1
    buffer_load_dwordx4 v[92:95], v1, s[40:43], s60 offen offset:1024 sc1
    s_waitcnt vmcnt(0)
    s_branch L_ochk3
L_sp1:
    ds_read_u8 v127, v125 offset:0
    s_waitcnt lgkmcnt(0)
    v_cmp_eq_u32 vcc, 0, v127
    s_nop 0
    s_cbranch_vccnz L_sp1
    s_branch L_spr1
L_sp2:
    ds_read_u8 v127, v125 offset:8
    s_waitcnt lgkmcnt(0)
    v_cmp_eq_u32 vcc, 0, v127
    s_nop 0
    s_cbranch_vccnz L_sp2
    s_branch L_spr2
L_sp3:
    ds_read_u8 v127, v126 offset:16
    s_waitcnt lgkmcnt(0)
    v_cmp_eq_u32 vcc, 0, v127
    s_nop 0
    s_cbranch_vccnz L_sp3
    s_branch L_spr3
L_sp4:
    ds_read_u8 v127, v125 offset:24
    s_waitcnt lgkmcnt(0)
    v_cmp_eq_u32 vcc, 0, v127
    s_nop 0
    s_cbranch_vccnz L_sp4
    s_branch L_spr4
L_sp5:
    ds_read_u8 v127, v125 offset:32
    s_waitcnt lgkmcnt(0)
    v_cmp_eq_u32 vcc, 0, v127
    s_nop 0
    s_cbranch_vccnz L_sp5
    s_branch L_spr5
L_sp6:
    ds_read_u8 v127, v126 offset:40
    s_waitcnt lgkmcnt(0)
    v_cmp_eq_u32 vcc, 0, v127
    s_nop 0
    s_cbranch_vccnz L_sp6
    s_branch L_spr6
L_sp7:
    ds_read_u8 v127, v126 offset:48
    s_waitcnt lgkmcnt(0)
    v_cmp_eq_u32 vcc, 0, v127
    s_nop 0
    s_cbranch_vccnz L_sp7
    s_branch L_spr7
L_sp8:
    ds_read_u8 v127, v125 offset:56
    s_waitcnt lgkmcnt(0)
    v_cmp_eq_u32 vcc, 0, v127
    s_nop 0
    s_cbranch_vccnz L_sp8
    s_branch L_spr8
L_chkc3:
    s_sub_u32 s71, s71, 1
    s_cbranch_scc1 L_chkc2
    buffer_load_dwordx4 v[120:123], v1, s[40:43], s57 offen sc1
    s_waitcnt vmcnt(0)
    s_branch L_chkc1
L_epoch:
    s_mov_b64 exec, 1
    buffer_store_dword v15, v1, s[40:43], 0 offen sc1
    s_mov_b64 exec, -1
    s_branch L_chkc_r
L_fallback:
    s_mov_b32 s70, -1
    s_setprio 0
    s_waitcnt lgkmcnt(0)
    s_barrier
    s_mov_b64 exec, 0xffff
    ds_write_b64 v130, v[128:129]
    s_mov_b64 exec, -1
    s_waitcnt lgkmcnt(0)
    s_add_u32 m0, s28, 32768
    s_add_u32 s66, s3, 0
    buffer_load_dwordx4 v1, s[40:43], s66 offen offset:0 sc1 lds
    buffer_load_dwordx4 v1, s[40:43], s66 offen offset:1024 sc1 lds
    buffer_load_dwordx4 v1, s[40:43], s66 offen offset:2048 sc1 lds
    buffer_load_dwordx4 v1, s[40:43], s66 offen offset:3072 sc1 lds
    s_add_u32 m0, s28, 65536
    s_add_u32 s66, s3, 32768
    buffer_load_dwordx4 v1, s[40:43], s66 offen offset:0 sc1 lds
    buffer_load_dwordx4 v1, s[40:43], s66 offen offset:1024 sc1 lds
    buffer_load_dwordx4 v1, s[40:43], s66 offen offset:2048 sc1 lds
    buffer_load_dwordx4 v1, s[40:43], s66 offen offset:3072 sc1 lds
    s_mov_b32 exec_lo, 0
    v_mov_b32 v22, 0
    v_mov_b32 v23, 0
    v_mov_b32 v138, 0
    v_mov_b32 v139, 0
    s_mov_b32 exec_lo, -1
    v_mov_b32 v14, 0xff800000
    v_mov_b32 v183, 0xff800000
    s_mov_b32 s60, s78
    s_mov_b32 s65, 0
L_fb1:
    buffer_load_dwordx4 v[24:27], v1, s[40:43], s60 offen sc1
    buffer_load_dwordx4 v[28:31], v1, s[40:43], s60 offen offset:1024 sc1
    s_waitcnt vmcnt(0)
    v_mfma_f32_32x32x16_bf16 v[64:79], v[24:27], v[16:19], 0
    v_mfma_f32_32x32x16_bf16 v[64:79], v[28:31], v[20:23], v[64:79]
    v_mfma_f32_32x32x16_bf16 v[48:63], v[24:27], v[132:135], 0
    v_mfma_f32_32x32x16_bf16 v[48:63], v[28:31], v[136:139], v[48:63]
    s_add_u32 s60, s60, 4096
    s_add_u32 s65, s65, 1
    s_nop 7
    v_max3_f32 v14, v64, v65, v14
    v_max3_f32 v14, v66, v67, v14
    v_max3_f32 v14, v68, v69, v14
    v_max3_f32 v14, v70, v71, v14
    v_max3_f32 v14, v72, v73, v14
    v_max3_f32 v14, v74, v75, v14
    v_max3_f32 v14, v76, v77, v14
    v_max3_f32 v14, v78, v79, v14
    v_max3_f32 v183, v48, v49, v183
    v_max3_f32 v183, v50, v51, v183
    v_max3_f32 v183, v52, v53, v183
    v_max3_f32 v183, v54, v55, v183
    v_max3_f32 v183, v56, v57, v183
    v_max3_f32 v183, v58, v59, v183
    v_max3_f32 v183, v60, v61, v183
    v_max3_f32 v183, v62, v63, v183
    s_cmp_lt_u32 s65, 64
    s_cbranch_scc1 L_fb1
    s_branch L_att
L_codeend:
    .fill 362, 4, 0xbf810000
.section .rodata,"a"
.p2align 6
.amdhsa_kernel concat_heads__softmax_full_mha__ssm_conv_h3__prompt_kernel
  .amdhsa_next_free_vgpr 256
  .amdhsa_next_free_sgpr 102
  .amdhsa_accum_offset 256
  .amdhsa_group_segment_fixed_size 0
  .amdhsa_kernarg_size 96
  .amdhsa_user_sgpr_count 2
  .amdhsa_user_sgpr_kernarg_segment_ptr 1
  .amdhsa_system_sgpr_workgroup_id_x 1
.end_amdhsa_kernel
```
